```python
import torch

def _softmax(x, axis=-1):
    return torch.softmax(x, dim=axis)
def _gelu(x):
    return torch.nn.functional.gelu(x, approximate="tanh")
def _silu(x):
    return torch.nn.functional.silu(x)
def _sigmoid(x):
    return torch.sigmoid(x)
def _layernorm(x, axis=-1, eps=1e-5):
    m = x.mean(dim=axis, keepdim=True)
    v = x.var(dim=axis, keepdim=True, unbiased=False)
    return (x - m) / torch.sqrt(v + eps)
def _scatter_add(tgt, idx, src, axis=0):
    return tgt.clone().index_add_(axis, idx, src)
def _segment_sum(src, seg, n):
    out = torch.zeros((n,) + src.shape[1:], dtype=src.dtype)
    return out.index_add_(0, seg, src)
def _pad(x, pw):
    flat = tuple(v for pair in reversed(pw) for v in pair)
    return torch.nn.functional.pad(x, flat)

kernel_name = 'concat_heads__spectral_fnet__sliding_local_dilated__prompt'

def setup_inputs():

    _w = (lambda a: (lambda t: t.to(torch.bfloat16) if t.is_floating_point() else t)(torch.as_tensor(a)))
    def _A_setup():
        B, S, D = 1, 2048, 512
        ns = torch.arange(S)[:, None] * torch.arange(S)[None, :]
        nd = torch.arange(D)[:, None] * torch.arange(D)[None, :]
        Ws_re = torch.cos(-2.0 * torch.pi * ns / S).to(float)
        Ws_im = torch.sin(-2.0 * torch.pi * ns / S).to(float)
        Wd_re = torch.cos(-2.0 * torch.pi * nd / D).to(float)
        Wd_im = torch.sin(-2.0 * torch.pi * nd / D).to(float)
        return {
            "x": _w((lambda *s: torch.randn(*s, dtype=torch.bfloat16) * 0.05)(B, S, D)),
            "dft_seq_re": _w(Ws_re),
            "dft_seq_im": _w(Ws_im),
            "dft_hid_re": _w(Wd_re),
            "dft_hid_im": _w(Wd_im),
        }
    _A_in = _A_setup()

    def _B_setup():
        B, S, D = 1, 2048, 512
        return {
            "x": _w((lambda *s: torch.randn(*s, dtype=torch.bfloat16) * 0.2)(B, S, D)),
            "wqkv": _w((lambda *s: torch.randn(*s, dtype=torch.bfloat16) * 0.8)(D, 3 * D)),
            "wo": _w((lambda *s: torch.randn(*s, dtype=torch.bfloat16) * 0.2)(D, D)),
        }
    _B_in = _B_setup()

    return {
        "A_x": _A_in["x"],
        "A_dft_seq_re": _A_in["dft_seq_re"],
        "A_dft_seq_im": _A_in["dft_seq_im"],
        "A_dft_hid_re": _A_in["dft_hid_re"],
        "A_dft_hid_im": _A_in["dft_hid_im"],
        "B_x": _B_in["x"],
        "B_wqkv": _B_in["wqkv"],
        "B_wo": _B_in["wo"],
    }

def reference(A_x, A_dft_seq_re, A_dft_seq_im, A_dft_hid_re, A_dft_hid_im, B_x, B_wqkv, B_wo):
    def _A_ref(x, dft_seq_re, dft_seq_im, dft_hid_re, dft_hid_im):
        a = torch.einsum("bsd,ed->bse", x, dft_hid_re)
        b = torch.einsum("bsd,ed->bse", x, dft_hid_im)
        y = torch.einsum("ts,bse->bte", dft_seq_re, a) - torch.einsum("ts,bse->bte", dft_seq_im, b)
        return y

    def _B_ref(x, wqkv, wo):
        B, S, D = x.shape
        H = 32; Dh = D // H
        W, dil = 8, 2
        qkv = (lambda x, *d: x.permute(*d))((x @ wqkv).reshape(B, S, 3, H, Dh), 2, 0, 3, 1, 4)
        q, k, v = qkv[0], qkv[1], qkv[2]
        scale = Dh ** -0.5
        pos = torch.arange(S)
        off = torch.arange(W) * dil
        idx = pos[:, None] - off[None, :]
        mask = idx >= 0
        idx_c = torch.where(mask, idx, 0).reshape(-1)
        kg = k[:, :, idx_c, :].reshape(B, H, S, W, Dh)
        vg = v[:, :, idx_c, :].reshape(B, H, S, W, Dh)
        logits = torch.einsum("bhsd,bhswd->bhsw", q, kg) * scale
        logits = torch.where(mask[None, None, :, :], logits, -1e9)
        attn = _softmax(logits, axis=-1)
        o = torch.einsum("bhsw,bhswd->bhsd", attn, vg)
        return (lambda x, *d: x.permute(*d))(o, 0, 2, 1, 3).reshape(B, S, D) @ wo

    a = _A_ref(A_x, A_dft_seq_re, A_dft_seq_im, A_dft_hid_re, A_dft_hid_im)
    b = _B_ref(B_x, B_wqkv, B_wo)
    return torch.concatenate([a, b], axis=-1)
```

```asm
; @launch kernel=fn_stage1_kernel grid=(256,1,1) block=(512,1,1) lds=155648
; @launch kernel=fn_stage2_kernel grid=(256,1,1) block=(512,1,1) lds=131072
.amdgcn_target "amdgcn-amd-amdhsa--gfx950"
.text
.globl fn_stage1_kernel
.p2align 8
.type fn_stage1_kernel,@function
fn_stage1_kernel:
  s_cmp_ge_u32 s2, 256
  s_cbranch_scc1 K1_END
  s_load_dwordx4 s[12:15], s[0:1], 40
  s_load_dwordx2 s[8:9], s[0:1], 0
  s_load_dwordx2 s[20:21], s[0:1], 80
  v_lshrrev_b32 v3, 6, v0
  v_and_b32 v0, 63, v0
  v_readfirstlane_b32 s24, v3
  s_and_b32 s32, s2, 7
  s_lshr_b32 s33, s2, 3
  s_lshr_b32 s34, s32, 1
  s_lshl_b32 s34, s34, 3
  s_lshr_b32 s35, s33, 2
  s_add_u32 s25, s34, s35
  s_and_b32 s34, s32, 1
  s_lshl_b32 s34, s34, 2
  s_and_b32 s35, s33, 3
  s_add_u32 s26, s34, s35
  v_and_b32 v1, 15, v0
  v_lshrrev_b32 v2, 4, v0
  s_and_b32 s30, s24, 3
  s_mov_b32 s22, 7340032
  s_mov_b32 s23, 0x20000
  s_cmp_lt_u32 s24, 4
  s_cbranch_scc1 K1_COMPUTE
  s_lshl_b32 s27, s26, 1
  s_add_u32 s27, s27, s25
  v_and_b32 v4, 7, v0
  v_xor_b32 v4, v4, v2
  v_lshlrev_b32 v4, 4, v4
  v_lshrrev_b32 v3, 3, v0
  v_lshl_add_u32 v8, v3, 10, v4
  v_xor_b32 v12, 64, v8
  v_add_u32 v12, 8192, v12
  s_and_b32 s34, s30, 1
  s_lshl_b32 s34, s34, 6
  v_xor_b32 v13, s34, v8
  s_lshl_b32 s34, s25, 16
  s_lshl_b32 s35, s30, 14
  s_add_u32 s36, s34, s35
  s_lshl_b32 s35, s30, 13
  s_add_u32 s37, s34, s35
  s_sub_u32 s37, s37, 16384
  s_max_i32 s37, s37, 0
  s_lshl_b32 s34, s30, 2
  v_add_u32 v3, s34, v2
  s_and_b32 s34, s34, 8
  v_lshl_add_u32 v4, v2, 1, s34
  v_xor_b32 v4, v1, v4
  v_mul_u32_u24 v3, 3072, v3
  v_and_b32 v5, 7, v4
  v_lshl_add_u32 v3, v5, 4, v3
  v_lshrrev_b32 v4, 3, v4
  v_lshl_add_u32 v9, v4, 10, v3
  v_mul_u32_u24 v4, 98304, v4
  v_add_u32 v10, v4, v3
  s_lshl_b32 s38, s26, 7
  s_lshl_b32 s39, s30, 10
  s_lshl_b32 s46, s30, 11
  s_cmp_lt_u32 s30, 2
  s_cselect_b64 s[40:41], -1, 0
  s_mov_b32 s47, 0
  s_mov_b32 s31, 0
  s_waitcnt lgkmcnt(0)
  s_mov_b32 s16, s14
  s_mov_b32 s17, s15
  s_mov_b32 s14, 0x200000
  s_mov_b32 s15, 0x20000
  s_mov_b32 s18, 0x180000
  s_mov_b32 s19, 0x20000
  s_call_b64 s[54:55], K1_ISSUE
  s_call_b64 s[54:55], K1_ISSUE
  s_waitcnt vmcnt(8)
  s_barrier
  s_call_b64 s[54:55], K1_ISSUE
  s_mov_b32 s10, 0x200000
  s_mov_b32 s11, 0x20000
  s_lshl_b32 s34, s32, 5
  s_add_u32 s34, s34, s33
  s_lshr_b32 s28, s34, 1
  s_and_b32 s29, s34, 1
  v_lshlrev_b32 v6, 4, v0
  s_lshl_b32 s34, s30, 9
  s_add_u32 s34, s34, s28
  s_lshl_b32 s34, s34, 10
  s_lshl_b32 s35, s30, 12
  s_add_u32 m0, s35, 139264
  s_nop 0
  buffer_load_dwordx4 v6, s[8:11], s34 offen lds
  s_add_u32 m0, m0, 1024
  s_add_u32 s34, s34, 131072
  buffer_load_dwordx4 v6, s[8:11], s34 offen lds
  s_add_u32 m0, m0, 1024
  s_add_u32 s34, s34, 131072
  buffer_load_dwordx4 v6, s[8:11], s34 offen lds
  s_add_u32 m0, m0, 1024
  s_add_u32 s34, s34, 131072
  buffer_load_dwordx4 v6, s[8:11], s34 offen lds
  s_waitcnt vmcnt(12)
  s_barrier
  s_call_b64 s[54:55], K1_ISSUE
  s_call_b64 s[54:55], K1_ISSUE
  s_waitcnt vmcnt(20)
  s_barrier
  s_call_b64 s[54:55], K1_ISSUE
  s_lshl_b32 s34, s29, 4
  v_add_u32 v3, s34, v1
  v_cvt_f32_u32 v3, v3
  v_lshlrev_b32 v4, 2, v2
  v_cvt_f32_u32 v4, v4
  v_cvt_f32_u32 v5, v1
  v_mul_f32 v3, 0x3d000000, v3
  v_mul_f32 v48, v4, v3
  v_fmamk_f32 v49, v3, 0x3f800000, v48
  v_fmamk_f32 v50, v3, 0x40000000, v48
  v_fmamk_f32 v51, v3, 0x40400000, v48
  v_fmamk_f32 v52, v3, 0x41800000, v48
  v_fmamk_f32 v53, v3, 0x41880000, v48
  v_fmamk_f32 v54, v3, 0x41900000, v48
  v_fmamk_f32 v55, v3, 0x41980000, v48
  v_cos_f32 v56, v48
  v_sin_f32 v64, v48
  v_cos_f32 v57, v49
  v_sin_f32 v65, v49
  v_cos_f32 v58, v50
  v_sin_f32 v66, v50
  v_cos_f32 v59, v51
  v_sin_f32 v67, v51
  v_cos_f32 v60, v52
  v_sin_f32 v68, v52
  v_cos_f32 v61, v53
  v_sin_f32 v69, v53
  v_cos_f32 v62, v54
  v_sin_f32 v70, v54
  v_cos_f32 v63, v55
  v_sin_f32 v71, v55
  v_mul_f32 v48, 0x3d800000, v48
  v_mul_f32 v49, 0x3d800000, v49
  v_mul_f32 v50, 0x3d800000, v50
  v_mul_f32 v51, 0x3d800000, v51
  v_cvt_pk_bf16_f32 v20, v56, v57
  v_cvt_pk_bf16_f32 v24, -v64, -v65
  v_cvt_pk_bf16_f32 v21, v58, v59
  v_cvt_pk_bf16_f32 v25, -v66, -v67
  v_cvt_pk_bf16_f32 v22, v60, v61
  v_cvt_pk_bf16_f32 v26, -v68, -v69
  v_cvt_pk_bf16_f32 v23, v62, v63
  v_cvt_pk_bf16_f32 v27, -v70, -v71
  s_waitcnt vmcnt(16)
  s_barrier
  s_call_b64 s[54:55], K1_ISSUE
  v_cos_f32 v28, v48
  v_sin_f32 v32, v48
  v_cos_f32 v29, v49
  v_sin_f32 v33, v49
  v_cos_f32 v30, v50
  v_sin_f32 v34, v50
  v_cos_f32 v31, v51
  v_sin_f32 v35, v51
  v_mul_f32 v5, 0x3d800000, v5
  v_mul_f32 v48, v4, v5
  v_fmamk_f32 v49, v5, 0x3f800000, v48
  v_fmamk_f32 v50, v5, 0x40000000, v48
  v_fmamk_f32 v51, v5, 0x40400000, v48
  v_cos_f32 v56, v48
  v_sin_f32 v64, v48
  v_cos_f32 v57, v49
  v_sin_f32 v65, v49
  v_cos_f32 v58, v50
  v_sin_f32 v66, v50
  v_cos_f32 v59, v51
  v_sin_f32 v67, v51
  v_cvt_pk_bf16_f32 v36, v56, v64
  v_cvt_pk_bf16_f32 v40, -v64, v56
  v_cvt_pk_bf16_f32 v37, v57, v65
  v_cvt_pk_bf16_f32 v41, -v65, v57
  v_cvt_pk_bf16_f32 v38, v58, v66
  v_cvt_pk_bf16_f32 v42, -v66, v58
  v_cvt_pk_bf16_f32 v39, v59, v67
  v_cvt_pk_bf16_f32 v43, -v67, v59
  s_lshl_b32 s34, s30, 12
  s_add_u32 s34, s34, 139264
  v_lshl_add_u32 v3, v0, 3, s34
  v_lshl_add_u32 v5, v2, 2, 0
  v_xor_b32 v6, v1, v5
  v_lshlrev_b32 v6, 4, v6
  v_lshl_add_u32 v6, v5, 8, v6
  v_add_u32 v44, s34, v6
  v_lshl_add_u32 v5, v2, 2, 1
  v_xor_b32 v6, v1, v5
  v_lshlrev_b32 v6, 4, v6
  v_lshl_add_u32 v6, v5, 8, v6
  v_add_u32 v45, s34, v6
  v_lshl_add_u32 v5, v2, 2, 2
  v_xor_b32 v6, v1, v5
  v_lshlrev_b32 v6, 4, v6
  v_lshl_add_u32 v6, v5, 8, v6
  v_add_u32 v46, s34, v6
  v_lshl_add_u32 v5, v2, 2, 3
  v_xor_b32 v6, v1, v5
  v_lshlrev_b32 v6, 4, v6
  v_lshl_add_u32 v6, v5, 8, v6
  v_add_u32 v47, s34, v6
  s_waitcnt vmcnt(16)
  ds_read_b64_tr_b16 v[48:49], v3 offset:0
  ds_read_b64_tr_b16 v[50:51], v3 offset:512
  ds_read_b64_tr_b16 v[52:53], v3 offset:1024
  ds_read_b64_tr_b16 v[54:55], v3 offset:1536
  ds_read_b64_tr_b16 v[56:57], v3 offset:2048
  ds_read_b64_tr_b16 v[58:59], v3 offset:2560
  ds_read_b64_tr_b16 v[60:61], v3 offset:3072
  ds_read_b64_tr_b16 v[62:63], v3 offset:3584
  s_barrier
  s_call_b64 s[54:55], K1_ISSUE
  s_waitcnt lgkmcnt(0)
  v_mfma_f32_16x16x32_bf16 v[64:67], v[48:51], v[20:23], 0
  v_mfma_f32_16x16x32_bf16 v[80:83], v[48:51], v[24:27], 0
  v_mfma_f32_16x16x32_bf16 v[68:71], v[52:55], v[20:23], 0
  v_mfma_f32_16x16x32_bf16 v[84:87], v[52:55], v[24:27], 0
  v_mfma_f32_16x16x32_bf16 v[72:75], v[56:59], v[20:23], 0
  v_mfma_f32_16x16x32_bf16 v[88:91], v[56:59], v[24:27], 0
  v_mfma_f32_16x16x32_bf16 v[76:79], v[60:63], v[20:23], 0
  v_mfma_f32_16x16x32_bf16 v[92:95], v[60:63], v[24:27], 0
  s_nop 0
  v_mul_f32 v48, v64, v28
  v_fmac_f32 v48, v80, v32
  v_mul_f32 v80, v80, v28
  v_fma_f32 v80, -v64, v32, v80
  v_mul_f32 v49, v65, v29
  v_fmac_f32 v49, v81, v33
  v_mul_f32 v81, v81, v29
  v_fma_f32 v81, -v65, v33, v81
  v_mul_f32 v50, v66, v30
  v_fmac_f32 v50, v82, v34
  v_mul_f32 v82, v82, v30
  v_fma_f32 v82, -v66, v34, v82
  v_mul_f32 v51, v67, v31
  v_fmac_f32 v51, v83, v35
  v_mul_f32 v83, v83, v31
  v_fma_f32 v83, -v67, v35, v83
  v_cvt_pk_bf16_f32 v96, v48, v80
  v_cvt_pk_bf16_f32 v97, v49, v81
  v_cvt_pk_bf16_f32 v98, v50, v82
  v_cvt_pk_bf16_f32 v99, v51, v83
  s_nop 1
  v_mfma_f32_16x16x32_bf16 v[48:51], v[96:99], v[36:39], 0
  v_mfma_f32_16x16x32_bf16 v[64:67], v[96:99], v[40:43], 0
  v_mul_f32 v52, v68, v28
  v_fmac_f32 v52, v84, v32
  v_mul_f32 v84, v84, v28
  v_fma_f32 v84, -v68, v32, v84
  v_mul_f32 v53, v69, v29
  v_fmac_f32 v53, v85, v33
  v_mul_f32 v85, v85, v29
  v_fma_f32 v85, -v69, v33, v85
  v_mul_f32 v54, v70, v30
  v_fmac_f32 v54, v86, v34
  v_mul_f32 v86, v86, v30
  v_fma_f32 v86, -v70, v34, v86
  v_mul_f32 v55, v71, v31
  v_fmac_f32 v55, v87, v35
  v_mul_f32 v87, v87, v31
  v_fma_f32 v87, -v71, v35, v87
  v_cvt_pk_bf16_f32 v100, v52, v84
  v_cvt_pk_bf16_f32 v101, v53, v85
  v_cvt_pk_bf16_f32 v102, v54, v86
  v_cvt_pk_bf16_f32 v103, v55, v87
  s_nop 1
  v_mfma_f32_16x16x32_bf16 v[52:55], v[100:103], v[36:39], 0
  v_mfma_f32_16x16x32_bf16 v[68:71], v[100:103], v[40:43], 0
  s_waitcnt vmcnt(16)
  s_barrier
  v_mul_f32 v56, v72, v28
  v_fmac_f32 v56, v88, v32
  v_mul_f32 v88, v88, v28
  v_fma_f32 v88, -v72, v32, v88
  v_mul_f32 v57, v73, v29
  v_fmac_f32 v57, v89, v33
  v_mul_f32 v89, v89, v29
  v_fma_f32 v89, -v73, v33, v89
  v_mul_f32 v58, v74, v30
  v_fmac_f32 v58, v90, v34
  v_mul_f32 v90, v90, v30
  v_fma_f32 v90, -v74, v34, v90
  v_mul_f32 v59, v75, v31
  v_fmac_f32 v59, v91, v35
  v_mul_f32 v91, v91, v31
  v_fma_f32 v91, -v75, v35, v91
  v_cvt_pk_bf16_f32 v104, v56, v88
  v_cvt_pk_bf16_f32 v105, v57, v89
  v_cvt_pk_bf16_f32 v106, v58, v90
  v_cvt_pk_bf16_f32 v107, v59, v91
  s_nop 1
  v_mfma_f32_16x16x32_bf16 v[56:59], v[104:107], v[36:39], 0
  v_mfma_f32_16x16x32_bf16 v[72:75], v[104:107], v[40:43], 0
  v_mul_f32 v60, v76, v28
  v_fmac_f32 v60, v92, v32
  v_mul_f32 v92, v92, v28
  v_fma_f32 v92, -v76, v32, v92
  v_mul_f32 v61, v77, v29
  v_fmac_f32 v61, v93, v33
  v_mul_f32 v93, v93, v29
  v_fma_f32 v93, -v77, v33, v93
  v_mul_f32 v62, v78, v30
  v_fmac_f32 v62, v94, v34
  v_mul_f32 v94, v94, v30
  v_fma_f32 v94, -v78, v34, v94
  v_mul_f32 v63, v79, v31
  v_fmac_f32 v63, v95, v35
  v_mul_f32 v95, v95, v31
  v_fma_f32 v95, -v79, v35, v95
  v_cvt_pk_bf16_f32 v108, v60, v92
  v_cvt_pk_bf16_f32 v109, v61, v93
  v_cvt_pk_bf16_f32 v110, v62, v94
  v_cvt_pk_bf16_f32 v111, v63, v95
  s_nop 1
  v_mfma_f32_16x16x32_bf16 v[60:63], v[108:111], v[36:39], 0
  v_mfma_f32_16x16x32_bf16 v[76:79], v[108:111], v[40:43], 0
  s_lshl_b32 s34, s30, 2
  v_xor_b32 v5, s34, v1
  v_lshlrev_b32 v5, 4, v5
  v_lshl_add_u32 v5, v1, 8, v5
  v_lshl_add_u32 v5, v2, 12, v5
  v_add_u32 v5, 139264, v5
  v_cvt_pk_bf16_f32 v96, v48, v64
  v_cvt_pk_bf16_f32 v97, v52, v68
  v_cvt_pk_bf16_f32 v98, v56, v72
  v_cvt_pk_bf16_f32 v99, v60, v76
  ds_write_b128 v44, v[96:99]
  v_cvt_pk_bf16_f32 v100, v49, v65
  v_cvt_pk_bf16_f32 v101, v53, v69
  v_cvt_pk_bf16_f32 v102, v57, v73
  v_cvt_pk_bf16_f32 v103, v61, v77
  ds_write_b128 v45, v[100:103]
  v_cvt_pk_bf16_f32 v104, v50, v66
  v_cvt_pk_bf16_f32 v105, v54, v70
  v_cvt_pk_bf16_f32 v106, v58, v74
  v_cvt_pk_bf16_f32 v107, v62, v78
  ds_write_b128 v46, v[104:107]
  v_cvt_pk_bf16_f32 v108, v51, v67
  v_cvt_pk_bf16_f32 v109, v55, v71
  v_cvt_pk_bf16_f32 v110, v59, v75
  v_cvt_pk_bf16_f32 v111, v63, v79
  ds_write_b128 v47, v[108:111]
  s_waitcnt vmcnt(8) lgkmcnt(0)
  s_barrier
  ds_read_b128 v[48:51], v5
  v_xor_b32 v6, 16, v5
  ds_read_b128 v[52:55], v6
  v_xor_b32 v6, 32, v5
  ds_read_b128 v[56:59], v6
  v_xor_b32 v6, 48, v5
  ds_read_b128 v[60:63], v6
  v_lshlrev_b32 v4, 18, v1
  v_lshl_add_u32 v4, v2, 4, v4
  s_lshl_b32 s46, s28, 1
  s_add_u32 s46, s46, s29
  s_lshl_b32 s46, s46, 10
  s_lshl_b32 s35, s30, 8
  s_add_u32 s46, s46, s35
  s_add_u32 s46, s46, 2097152
  s_waitcnt lgkmcnt(3)
  v_mfma_f32_16x16x32_bf16 v[64:67], v[48:51], v[36:39], 0
  v_mfma_f32_16x16x32_bf16 v[80:83], v[48:51], v[40:43], 0
  s_waitcnt lgkmcnt(2)
  v_mfma_f32_16x16x32_bf16 v[68:71], v[52:55], v[36:39], 0
  v_mfma_f32_16x16x32_bf16 v[84:87], v[52:55], v[40:43], 0
  s_waitcnt lgkmcnt(1)
  v_mfma_f32_16x16x32_bf16 v[72:75], v[56:59], v[36:39], 0
  v_mfma_f32_16x16x32_bf16 v[88:91], v[56:59], v[40:43], 0
  s_waitcnt lgkmcnt(0)
  v_mfma_f32_16x16x32_bf16 v[76:79], v[60:63], v[36:39], 0
  v_mfma_f32_16x16x32_bf16 v[92:95], v[60:63], v[40:43], 0
  s_waitcnt vmcnt(0)
  s_barrier
  v_cvt_pk_bf16_f32 v96, v64, v65
  v_cvt_pk_bf16_f32 v97, v66, v67
  v_cvt_pk_bf16_f32 v98, v80, v81
  v_cvt_pk_bf16_f32 v99, v82, v83
  buffer_store_dwordx4 v[96:99], v4, s[20:23], s46 offen offset:0
  v_cvt_pk_bf16_f32 v100, v68, v69
  v_cvt_pk_bf16_f32 v101, v70, v71
  v_cvt_pk_bf16_f32 v102, v84, v85
  v_cvt_pk_bf16_f32 v103, v86, v87
  buffer_store_dwordx4 v[100:103], v4, s[20:23], s46 offen offset:64
  v_cvt_pk_bf16_f32 v104, v72, v73
  v_cvt_pk_bf16_f32 v105, v74, v75
  v_cvt_pk_bf16_f32 v106, v88, v89
  v_cvt_pk_bf16_f32 v107, v90, v91
  buffer_store_dwordx4 v[104:107], v4, s[20:23], s46 offen offset:128
  v_cvt_pk_bf16_f32 v108, v76, v77
  v_cvt_pk_bf16_f32 v109, v78, v79
  v_cvt_pk_bf16_f32 v110, v92, v93
  v_cvt_pk_bf16_f32 v111, v94, v95
  buffer_store_dwordx4 v[108:111], v4, s[20:23], s46 offen offset:192
  s_load_dwordx4 s[12:15], s[0:1], 56
  s_lshl_b32 s34, s33, 14
  s_lshl_b32 s35, s30, 12
  s_add_u32 s34, s34, s35
  v_lshlrev_b32 v3, 6, v0
  s_lshl_b32 s35, s33, 17
  s_lshl_b32 s36, s30, 15
  s_add_u32 s35, s35, s36
  v_mov_b32 v5, 0
  s_waitcnt lgkmcnt(0)
  s_mov_b32 s16, s14
  s_mov_b32 s17, s15
  s_mov_b32 s14, 0x80000
  s_mov_b32 s15, 0x20000
  s_mov_b32 s18, 0x400000
  buffer_load_dword v6, v3, s[12:15], s34 offen
  s_mov_b64 exec, 1
  buffer_load_dword v4, v5, s[16:19], s35 offen
  s_endpgm
K1_ISSUE:
  s_add_u32 s42, s27, s47
  s_and_b32 s42, s42, 7
  s_lshl_b32 s43, s42, 7
  s_mul_i32 s42, s42, 196608
  s_add_u32 s42, s42, s38
  s_add_u32 s45, s31, s46
  s_add_u32 m0, s45, 2048
  s_add_u32 s44, s36, s43
  buffer_load_dwordx4 v8, s[12:15], s44 offen lds
  s_add_u32 m0, s45, 3072
  s_add_u32 s45, s31, s39
  buffer_load_dwordx4 v12, s[12:15], s44 offen lds
  s_add_u32 m0, s45, 10240
  s_add_u32 s44, s42, 0
  buffer_load_dwordx4 v9, s[16:19], s44 offen lds
  s_add_u32 m0, s45, 14336
  s_add_u32 s44, s42, 49152
  buffer_load_dwordx4 v9, s[16:19], s44 offen lds
  s_add_u32 m0, s45, 18432
  s_add_u32 s44, s42, 98304
  buffer_load_dwordx4 v9, s[16:19], s44 offen lds
  s_add_u32 m0, s45, 22528
  s_add_u32 s44, s42, 147456
  buffer_load_dwordx4 v9, s[16:19], s44 offen lds
  s_add_u32 m0, s45, 26624
  s_add_u32 s44, s42, 2048
  buffer_load_dwordx4 v10, s[16:19], s44 offen lds
  s_add_u32 m0, s45, 30720
  s_add_u32 s44, s42, 51200
  buffer_load_dwordx4 v10, s[16:19], s44 offen lds
  s_add_u32 m0, s45, 0
  s_add_u32 s44, s37, s43
  s_mov_b64 exec, s[40:41]
  buffer_load_dwordx4 v13, s[12:15], s44 offen lds
  s_mov_b64 exec, -1
  s_add_u32 s47, s47, 1
  s_add_u32 s31, s31, 34816
  s_cmp_eq_u32 s31, 139264
  s_cselect_b32 s31, 0, s31
  s_nop 3
  s_setpc_b64 s[54:55]
K1_COMPUTE:
  s_mov_b32 s58, 2097152
  v_lshrrev_b32 v3, 1, v1
  v_xor_b32 v3, v3, v2
  v_lshlrev_b32 v3, 4, v3
  v_lshl_add_u32 v8, v1, 7, v3
  v_xor_b32 v9, 64, v8
  v_add_u32 v12, 69632, v8
  v_add_u32 v13, 69632, v9
  v_bfe_u32 v3, v0, 2, 2
  v_and_b32 v4, 3, v0
  v_lshl_add_u32 v5, v2, 3, v3
  v_lshlrev_b32 v5, 8, v5
  v_lshrrev_b32 v6, 1, v4
  s_lshl_b32 s35, s30, 1
  v_add_u32 v6, s35, v6
  v_lshlrev_b32 v3, 1, v3
  v_xor_b32 v6, v6, v3
  v_and_b32 v3, 1, v2
  v_lshlrev_b32 v3, 3, v3
  v_xor_b32 v6, v6, v3
  v_lshl_add_u32 v5, v6, 4, v5
  v_and_b32 v4, 1, v4
  v_lshl_add_u32 v10, v4, 3, v5
  v_xor_b32 v11, 128, v10
  v_add_u32 v14, 69632, v10
  v_add_u32 v15, 69632, v11
  v_lshlrev_b32 v3, 2, v2
  v_add_u32 v4, 0, v3
  v_cmp_le_u32 s[48:49], v4, v1
  v_add_u32 v4, 1, v3
  v_cmp_le_u32 s[50:51], v4, v1
  v_add_u32 v4, 2, v3
  v_cmp_le_u32 s[52:53], v4, v1
  v_add_u32 v4, 3, v3
  v_cmp_le_u32 s[54:55], v4, v1
  v_and_b32 v4, 1, v1
  v_cmp_eq_u32 s[56:57], 1, v4
  v_mov_b32 v5, 0xffff
  v_mov_b32 v6, 0xffff0000
  v_cndmask_b32 v5, v5, v6, s[56:57]
  v_add_u32 v3, v3, v4
  v_cmp_le_u32 vcc, v3, v1
  s_nop 1
  v_cndmask_b32 v16, 0, v5, vcc
  v_cndmask_b32 v18, v5, 0, vcc
  v_add_u32 v3, 2, v3
  v_cmp_le_u32 vcc, v3, v1
  s_nop 1
  v_cndmask_b32 v17, 0, v5, vcc
  v_cndmask_b32 v19, v5, 0, vcc
  v_and_b32 v3, 1, v2
  v_lshlrev_b32 v3, 14, v3
  v_lshrrev_b32 v6, 1, v2
  v_lshl_add_u32 v3, v6, 8, v3
  v_lshl_add_u32 v3, v1, 4, v3
  s_lshl_b32 s47, s25, 16
  s_lshl_b32 s35, s26, 2
  s_add_u32 s35, s35, s30
  s_lshl_b32 s35, s35, 9
  s_add_u32 s47, s47, s35
  s_add_u32 s45, s47, 32768
  s_waitcnt lgkmcnt(0)
  s_barrier
  ds_read_b64_tr_b16 v[116:117], v11 offset:10240
  ds_read_b64_tr_b16 v[118:119], v11 offset:11264
  ds_read_b128 v[92:95], v8 offset:0
  ds_read_b64_tr_b16 v[120:121], v10 offset:26624
  ds_read_b64_tr_b16 v[122:123], v10 offset:27648
  ds_read_b64_tr_b16 v[112:113], v10 offset:10240
  ds_read_b64_tr_b16 v[114:115], v10 offset:11264
  ds_read_b128 v[96:99], v8 offset:2048
  ds_read_b128 v[100:103], v8 offset:4096
  ds_read_b128 v[104:107], v8 offset:6144
  ds_read_b128 v[108:111], v8 offset:8192
  s_waitcnt lgkmcnt(0)
  v_mfma_f32_16x16x32_bf16 v[36:39], v[116:119], v[92:95], 0
  ds_read_b64_tr_b16 v[148:149], v11 offset:18432
  ds_read_b64_tr_b16 v[150:151], v11 offset:19456
  v_mfma_f32_16x16x32_bf16 v[56:59], v[92:95], v[120:123], 0
  ds_read_b128 v[124:127], v9 offset:0
  ds_read_b64_tr_b16 v[152:153], v11 offset:26624
  v_mfma_f32_16x16x32_bf16 v[40:43], v[116:119], v[96:99], 0
  ds_read_b64_tr_b16 v[154:155], v11 offset:27648
  ds_read_b64_tr_b16 v[144:145], v10 offset:18432
  v_mfma_f32_16x16x32_bf16 v[60:63], v[96:99], v[120:123], 0
  ds_read_b64_tr_b16 v[146:147], v10 offset:19456
  ds_read_b128 v[128:131], v9 offset:2048
  v_mfma_f32_16x16x32_bf16 v[76:79], v[112:115], v[96:99], 0
  ds_read_b128 v[132:135], v9 offset:4096
  ds_read_b128 v[136:139], v9 offset:6144
  v_mfma_f32_16x16x32_bf16 v[44:47], v[116:119], v[100:103], 0
  ds_read_b128 v[140:143], v9 offset:8192
  v_mfma_f32_16x16x32_bf16 v[64:67], v[100:103], v[120:123], 0
  v_mfma_f32_16x16x32_bf16 v[80:83], v[112:115], v[100:103], 0
  v_mfma_f32_16x16x32_bf16 v[48:51], v[116:119], v[104:107], 0
  v_mfma_f32_16x16x32_bf16 v[68:71], v[104:107], v[120:123], 0
  v_mfma_f32_16x16x32_bf16 v[84:87], v[112:115], v[104:107], 0
  v_mfma_f32_16x16x32_bf16 v[52:55], v[116:119], v[108:111], 0
  v_mfma_f32_16x16x32_bf16 v[72:75], v[108:111], v[120:123], 0
  v_mfma_f32_16x16x32_bf16 v[88:91], v[112:115], v[108:111], 0
  s_waitcnt lgkmcnt(0)
  s_barrier
  v_mfma_f32_16x16x32_bf16 v[36:39], v[148:151], v[124:127], v[36:39]
  ds_read_b64_tr_b16 v[116:117], v11 offset:45056
  ds_read_b64_tr_b16 v[118:119], v11 offset:46080
  v_mfma_f32_16x16x32_bf16 v[56:59], v[124:127], v[152:155], v[56:59]
  ds_read_b128 v[92:95], v8 offset:34816
  ds_read_b64_tr_b16 v[120:121], v10 offset:61440
  v_mfma_f32_16x16x32_bf16 v[40:43], v[148:151], v[128:131], v[40:43]
  ds_read_b64_tr_b16 v[122:123], v10 offset:62464
  ds_read_b64_tr_b16 v[112:113], v10 offset:45056
  v_mfma_f32_16x16x32_bf16 v[60:63], v[128:131], v[152:155], v[60:63]
  ds_read_b64_tr_b16 v[114:115], v10 offset:46080
  ds_read_b128 v[96:99], v8 offset:36864
  v_mfma_f32_16x16x32_bf16 v[76:79], v[144:147], v[128:131], v[76:79]
  ds_read_b128 v[100:103], v8 offset:38912
  ds_read_b128 v[104:107], v8 offset:40960
  v_mfma_f32_16x16x32_bf16 v[44:47], v[148:151], v[132:135], v[44:47]
  ds_read_b128 v[108:111], v8 offset:43008
  v_mfma_f32_16x16x32_bf16 v[64:67], v[132:135], v[152:155], v[64:67]
  v_mfma_f32_16x16x32_bf16 v[80:83], v[144:147], v[132:135], v[80:83]
  v_mfma_f32_16x16x32_bf16 v[48:51], v[148:151], v[136:139], v[48:51]
  v_mfma_f32_16x16x32_bf16 v[68:71], v[136:139], v[152:155], v[68:71]
  v_mfma_f32_16x16x32_bf16 v[84:87], v[144:147], v[136:139], v[84:87]
  v_mfma_f32_16x16x32_bf16 v[52:55], v[148:151], v[140:143], v[52:55]
  v_mfma_f32_16x16x32_bf16 v[72:75], v[140:143], v[152:155], v[72:75]
  v_mfma_f32_16x16x32_bf16 v[88:91], v[144:147], v[140:143], v[88:91]
  s_waitcnt lgkmcnt(0)
  v_mfma_f32_16x16x32_bf16 v[36:39], v[116:119], v[92:95], v[36:39]
  ds_read_b64_tr_b16 v[148:149], v11 offset:53248
  ds_read_b64_tr_b16 v[150:151], v11 offset:54272
  v_mfma_f32_16x16x32_bf16 v[56:59], v[92:95], v[120:123], v[56:59]
  ds_read_b128 v[124:127], v9 offset:34816
  ds_read_b64_tr_b16 v[152:153], v11 offset:61440
  v_mfma_f32_16x16x32_bf16 v[40:43], v[116:119], v[96:99], v[40:43]
  ds_read_b64_tr_b16 v[154:155], v11 offset:62464
  ds_read_b64_tr_b16 v[144:145], v10 offset:53248
  v_mfma_f32_16x16x32_bf16 v[60:63], v[96:99], v[120:123], v[60:63]
  ds_read_b64_tr_b16 v[146:147], v10 offset:54272
  ds_read_b128 v[128:131], v9 offset:36864
  v_mfma_f32_16x16x32_bf16 v[76:79], v[112:115], v[96:99], v[76:79]
  ds_read_b128 v[132:135], v9 offset:38912
  ds_read_b128 v[136:139], v9 offset:40960
  v_mfma_f32_16x16x32_bf16 v[44:47], v[116:119], v[100:103], v[44:47]
  ds_read_b128 v[140:143], v9 offset:43008
  v_mfma_f32_16x16x32_bf16 v[64:67], v[100:103], v[120:123], v[64:67]
  v_mfma_f32_16x16x32_bf16 v[80:83], v[112:115], v[100:103], v[80:83]
  v_mfma_f32_16x16x32_bf16 v[48:51], v[116:119], v[104:107], v[48:51]
  v_mfma_f32_16x16x32_bf16 v[68:71], v[104:107], v[120:123], v[68:71]
  v_mfma_f32_16x16x32_bf16 v[84:87], v[112:115], v[104:107], v[84:87]
  v_mfma_f32_16x16x32_bf16 v[52:55], v[116:119], v[108:111], v[52:55]
  v_mfma_f32_16x16x32_bf16 v[72:75], v[108:111], v[120:123], v[72:75]
  v_mfma_f32_16x16x32_bf16 v[88:91], v[112:115], v[108:111], v[88:91]
  s_waitcnt lgkmcnt(0)
  s_barrier
  v_mfma_f32_16x16x32_bf16 v[36:39], v[148:151], v[124:127], v[36:39]
  ds_read_b64_tr_b16 v[116:117], v15 offset:10240
  ds_read_b64_tr_b16 v[118:119], v15 offset:11264
  v_mfma_f32_16x16x32_bf16 v[56:59], v[124:127], v[152:155], v[56:59]
  ds_read_b128 v[92:95], v12 offset:0
  ds_read_b64_tr_b16 v[120:121], v14 offset:26624
  v_mfma_f32_16x16x32_bf16 v[40:43], v[148:151], v[128:131], v[40:43]
  ds_read_b64_tr_b16 v[122:123], v14 offset:27648
  ds_read_b64_tr_b16 v[112:113], v14 offset:10240
  v_mfma_f32_16x16x32_bf16 v[60:63], v[128:131], v[152:155], v[60:63]
  ds_read_b64_tr_b16 v[114:115], v14 offset:11264
  ds_read_b128 v[96:99], v12 offset:2048
  v_mfma_f32_16x16x32_bf16 v[76:79], v[144:147], v[128:131], v[76:79]
  ds_read_b128 v[100:103], v12 offset:4096
  ds_read_b128 v[104:107], v12 offset:6144
  v_mfma_f32_16x16x32_bf16 v[44:47], v[148:151], v[132:135], v[44:47]
  ds_read_b128 v[108:111], v12 offset:8192
  v_mfma_f32_16x16x32_bf16 v[64:67], v[132:135], v[152:155], v[64:67]
  v_mfma_f32_16x16x32_bf16 v[80:83], v[144:147], v[132:135], v[80:83]
  v_mfma_f32_16x16x32_bf16 v[48:51], v[148:151], v[136:139], v[48:51]
  v_mfma_f32_16x16x32_bf16 v[68:71], v[136:139], v[152:155], v[68:71]
  v_mfma_f32_16x16x32_bf16 v[84:87], v[144:147], v[136:139], v[84:87]
  v_mfma_f32_16x16x32_bf16 v[52:55], v[148:151], v[140:143], v[52:55]
  v_mfma_f32_16x16x32_bf16 v[72:75], v[140:143], v[152:155], v[72:75]
  v_mfma_f32_16x16x32_bf16 v[88:91], v[144:147], v[140:143], v[88:91]
  s_waitcnt lgkmcnt(0)
  v_mfma_f32_16x16x32_bf16 v[36:39], v[116:119], v[92:95], v[36:39]
  ds_read_b64_tr_b16 v[148:149], v15 offset:18432
  ds_read_b64_tr_b16 v[150:151], v15 offset:19456
  v_mfma_f32_16x16x32_bf16 v[56:59], v[92:95], v[120:123], v[56:59]
  ds_read_b128 v[124:127], v13 offset:0
  ds_read_b64_tr_b16 v[152:153], v15 offset:26624
  v_mfma_f32_16x16x32_bf16 v[40:43], v[116:119], v[96:99], v[40:43]
  ds_read_b64_tr_b16 v[154:155], v15 offset:27648
  ds_read_b64_tr_b16 v[144:145], v14 offset:18432
  v_mfma_f32_16x16x32_bf16 v[60:63], v[96:99], v[120:123], v[60:63]
  ds_read_b64_tr_b16 v[146:147], v14 offset:19456
  ds_read_b128 v[128:131], v13 offset:2048
  v_mfma_f32_16x16x32_bf16 v[76:79], v[112:115], v[96:99], v[76:79]
  ds_read_b128 v[132:135], v13 offset:4096
  ds_read_b128 v[136:139], v13 offset:6144
  v_mfma_f32_16x16x32_bf16 v[44:47], v[116:119], v[100:103], v[44:47]
  ds_read_b128 v[140:143], v13 offset:8192
  v_mfma_f32_16x16x32_bf16 v[64:67], v[100:103], v[120:123], v[64:67]
  v_mfma_f32_16x16x32_bf16 v[80:83], v[112:115], v[100:103], v[80:83]
  v_mfma_f32_16x16x32_bf16 v[48:51], v[116:119], v[104:107], v[48:51]
  v_mfma_f32_16x16x32_bf16 v[68:71], v[104:107], v[120:123], v[68:71]
  v_mfma_f32_16x16x32_bf16 v[84:87], v[112:115], v[104:107], v[84:87]
  v_mfma_f32_16x16x32_bf16 v[52:55], v[116:119], v[108:111], v[52:55]
  v_mfma_f32_16x16x32_bf16 v[72:75], v[108:111], v[120:123], v[72:75]
  v_mfma_f32_16x16x32_bf16 v[88:91], v[112:115], v[108:111], v[88:91]
  s_waitcnt lgkmcnt(0)
  s_barrier
  v_mfma_f32_16x16x32_bf16 v[36:39], v[148:151], v[124:127], v[36:39]
  ds_read_b64_tr_b16 v[116:117], v15 offset:45056
  ds_read_b64_tr_b16 v[118:119], v15 offset:46080
  v_mfma_f32_16x16x32_bf16 v[56:59], v[124:127], v[152:155], v[56:59]
  ds_read_b128 v[92:95], v12 offset:34816
  ds_read_b64_tr_b16 v[120:121], v14 offset:61440
  v_mfma_f32_16x16x32_bf16 v[40:43], v[148:151], v[128:131], v[40:43]
  ds_read_b64_tr_b16 v[122:123], v14 offset:62464
  ds_read_b64_tr_b16 v[112:113], v14 offset:45056
  v_mfma_f32_16x16x32_bf16 v[60:63], v[128:131], v[152:155], v[60:63]
  ds_read_b64_tr_b16 v[114:115], v14 offset:46080
  ds_read_b128 v[96:99], v12 offset:36864
  v_mfma_f32_16x16x32_bf16 v[76:79], v[144:147], v[128:131], v[76:79]
  ds_read_b128 v[100:103], v12 offset:38912
  ds_read_b128 v[104:107], v12 offset:40960
  v_mfma_f32_16x16x32_bf16 v[44:47], v[148:151], v[132:135], v[44:47]
  ds_read_b128 v[108:111], v12 offset:43008
  v_mfma_f32_16x16x32_bf16 v[64:67], v[132:135], v[152:155], v[64:67]
  v_mfma_f32_16x16x32_bf16 v[80:83], v[144:147], v[132:135], v[80:83]
  v_mfma_f32_16x16x32_bf16 v[48:51], v[148:151], v[136:139], v[48:51]
  v_mfma_f32_16x16x32_bf16 v[68:71], v[136:139], v[152:155], v[68:71]
  v_mfma_f32_16x16x32_bf16 v[84:87], v[144:147], v[136:139], v[84:87]
  v_mfma_f32_16x16x32_bf16 v[52:55], v[148:151], v[140:143], v[52:55]
  v_mfma_f32_16x16x32_bf16 v[72:75], v[140:143], v[152:155], v[72:75]
  v_mfma_f32_16x16x32_bf16 v[88:91], v[144:147], v[140:143], v[88:91]
  s_waitcnt lgkmcnt(0)
  v_mfma_f32_16x16x32_bf16 v[36:39], v[116:119], v[92:95], v[36:39]
  ds_read_b64_tr_b16 v[148:149], v15 offset:53248
  ds_read_b64_tr_b16 v[150:151], v15 offset:54272
  v_mfma_f32_16x16x32_bf16 v[56:59], v[92:95], v[120:123], v[56:59]
  ds_read_b128 v[124:127], v13 offset:34816
  ds_read_b64_tr_b16 v[152:153], v15 offset:61440
  v_mfma_f32_16x16x32_bf16 v[40:43], v[116:119], v[96:99], v[40:43]
  ds_read_b64_tr_b16 v[154:155], v15 offset:62464
  ds_read_b64_tr_b16 v[144:145], v14 offset:53248
  v_mfma_f32_16x16x32_bf16 v[60:63], v[96:99], v[120:123], v[60:63]
  ds_read_b64_tr_b16 v[146:147], v14 offset:54272
  ds_read_b128 v[128:131], v13 offset:36864
  v_mfma_f32_16x16x32_bf16 v[76:79], v[112:115], v[96:99], v[76:79]
  ds_read_b128 v[132:135], v13 offset:38912
  ds_read_b128 v[136:139], v13 offset:40960
  v_mfma_f32_16x16x32_bf16 v[44:47], v[116:119], v[100:103], v[44:47]
  ds_read_b128 v[140:143], v13 offset:43008
  v_mfma_f32_16x16x32_bf16 v[64:67], v[100:103], v[120:123], v[64:67]
  v_mfma_f32_16x16x32_bf16 v[80:83], v[112:115], v[100:103], v[80:83]
  v_mfma_f32_16x16x32_bf16 v[48:51], v[116:119], v[104:107], v[48:51]
  v_mfma_f32_16x16x32_bf16 v[68:71], v[104:107], v[120:123], v[68:71]
  v_mfma_f32_16x16x32_bf16 v[84:87], v[112:115], v[104:107], v[84:87]
  v_mfma_f32_16x16x32_bf16 v[52:55], v[116:119], v[108:111], v[52:55]
  v_mfma_f32_16x16x32_bf16 v[72:75], v[108:111], v[120:123], v[72:75]
  v_mfma_f32_16x16x32_bf16 v[88:91], v[112:115], v[108:111], v[88:91]
  s_waitcnt lgkmcnt(0)
  s_barrier
  v_mfma_f32_16x16x32_bf16 v[36:39], v[148:151], v[124:127], v[36:39]
  ds_read_b64_tr_b16 v[116:117], v11 offset:10240
  ds_read_b64_tr_b16 v[118:119], v11 offset:11264
  v_mfma_f32_16x16x32_bf16 v[56:59], v[124:127], v[152:155], v[56:59]
  ds_read_b128 v[92:95], v8 offset:0
  ds_read_b64_tr_b16 v[120:121], v10 offset:26624
  v_mfma_f32_16x16x32_bf16 v[40:43], v[148:151], v[128:131], v[40:43]
  ds_read_b64_tr_b16 v[122:123], v10 offset:27648
  ds_read_b64_tr_b16 v[112:113], v10 offset:10240
  v_mfma_f32_16x16x32_bf16 v[60:63], v[128:131], v[152:155], v[60:63]
  ds_read_b64_tr_b16 v[114:115], v10 offset:11264
  ds_read_b128 v[96:99], v8 offset:2048
  v_mfma_f32_16x16x32_bf16 v[76:79], v[144:147], v[128:131], v[76:79]
  ds_read_b128 v[100:103], v8 offset:4096
  ds_read_b128 v[104:107], v8 offset:6144
  v_mfma_f32_16x16x32_bf16 v[44:47], v[148:151], v[132:135], v[44:47]
  ds_read_b128 v[108:111], v8 offset:8192
  v_mfma_f32_16x16x32_bf16 v[64:67], v[132:135], v[152:155], v[64:67]
  v_mfma_f32_16x16x32_bf16 v[80:83], v[144:147], v[132:135], v[80:83]
  v_mfma_f32_16x16x32_bf16 v[48:51], v[148:151], v[136:139], v[48:51]
  v_mfma_f32_16x16x32_bf16 v[68:71], v[136:139], v[152:155], v[68:71]
  v_mfma_f32_16x16x32_bf16 v[84:87], v[144:147], v[136:139], v[84:87]
  v_mfma_f32_16x16x32_bf16 v[52:55], v[148:151], v[140:143], v[52:55]
  v_mfma_f32_16x16x32_bf16 v[72:75], v[140:143], v[152:155], v[72:75]
  v_mfma_f32_16x16x32_bf16 v[88:91], v[144:147], v[140:143], v[88:91]
  s_waitcnt lgkmcnt(0)
  v_mfma_f32_16x16x32_bf16 v[36:39], v[116:119], v[92:95], v[36:39]
  ds_read_b64_tr_b16 v[148:149], v11 offset:18432
  ds_read_b64_tr_b16 v[150:151], v11 offset:19456
  v_mfma_f32_16x16x32_bf16 v[56:59], v[92:95], v[120:123], v[56:59]
  ds_read_b128 v[124:127], v9 offset:0
  ds_read_b64_tr_b16 v[152:153], v11 offset:26624
  v_mfma_f32_16x16x32_bf16 v[40:43], v[116:119], v[96:99], v[40:43]
  ds_read_b64_tr_b16 v[154:155], v11 offset:27648
  ds_read_b64_tr_b16 v[144:145], v10 offset:18432
  v_mfma_f32_16x16x32_bf16 v[60:63], v[96:99], v[120:123], v[60:63]
  ds_read_b64_tr_b16 v[146:147], v10 offset:19456
  ds_read_b128 v[128:131], v9 offset:2048
  v_mfma_f32_16x16x32_bf16 v[76:79], v[112:115], v[96:99], v[76:79]
  ds_read_b128 v[132:135], v9 offset:4096
  ds_read_b128 v[136:139], v9 offset:6144
  v_mfma_f32_16x16x32_bf16 v[44:47], v[116:119], v[100:103], v[44:47]
  ds_read_b128 v[140:143], v9 offset:8192
  v_mfma_f32_16x16x32_bf16 v[64:67], v[100:103], v[120:123], v[64:67]
  v_mfma_f32_16x16x32_bf16 v[80:83], v[112:115], v[100:103], v[80:83]
  v_mfma_f32_16x16x32_bf16 v[48:51], v[116:119], v[104:107], v[48:51]
  v_mfma_f32_16x16x32_bf16 v[68:71], v[104:107], v[120:123], v[68:71]
  v_mfma_f32_16x16x32_bf16 v[84:87], v[112:115], v[104:107], v[84:87]
  v_mfma_f32_16x16x32_bf16 v[52:55], v[116:119], v[108:111], v[52:55]
  v_mfma_f32_16x16x32_bf16 v[72:75], v[108:111], v[120:123], v[72:75]
  v_mfma_f32_16x16x32_bf16 v[88:91], v[112:115], v[108:111], v[88:91]
  s_waitcnt lgkmcnt(0)
  s_barrier
  v_mfma_f32_16x16x32_bf16 v[36:39], v[148:151], v[124:127], v[36:39]
  ds_read_b64_tr_b16 v[116:117], v11 offset:45056
  ds_read_b64_tr_b16 v[118:119], v11 offset:46080
  v_mfma_f32_16x16x32_bf16 v[56:59], v[124:127], v[152:155], v[56:59]
  ds_read_b128 v[92:95], v8 offset:34816
  ds_read_b64_tr_b16 v[120:121], v10 offset:61440
  v_mfma_f32_16x16x32_bf16 v[40:43], v[148:151], v[128:131], v[40:43]
  ds_read_b64_tr_b16 v[122:123], v10 offset:62464
  ds_read_b64_tr_b16 v[112:113], v10 offset:45056
  v_mfma_f32_16x16x32_bf16 v[60:63], v[128:131], v[152:155], v[60:63]
  ds_read_b64_tr_b16 v[114:115], v10 offset:46080
  ds_read_b128 v[96:99], v8 offset:36864
  v_mfma_f32_16x16x32_bf16 v[76:79], v[144:147], v[128:131], v[76:79]
  ds_read_b128 v[100:103], v8 offset:38912
  ds_read_b128 v[104:107], v8 offset:40960
  v_mfma_f32_16x16x32_bf16 v[44:47], v[148:151], v[132:135], v[44:47]
  ds_read_b128 v[108:111], v8 offset:43008
  v_mfma_f32_16x16x32_bf16 v[64:67], v[132:135], v[152:155], v[64:67]
  v_mfma_f32_16x16x32_bf16 v[80:83], v[144:147], v[132:135], v[80:83]
  v_mfma_f32_16x16x32_bf16 v[48:51], v[148:151], v[136:139], v[48:51]
  v_mfma_f32_16x16x32_bf16 v[68:71], v[136:139], v[152:155], v[68:71]
  v_mfma_f32_16x16x32_bf16 v[84:87], v[144:147], v[136:139], v[84:87]
  v_mfma_f32_16x16x32_bf16 v[52:55], v[148:151], v[140:143], v[52:55]
  v_mfma_f32_16x16x32_bf16 v[72:75], v[140:143], v[152:155], v[72:75]
  v_mfma_f32_16x16x32_bf16 v[88:91], v[144:147], v[140:143], v[88:91]
  s_waitcnt lgkmcnt(0)
  v_mfma_f32_16x16x32_bf16 v[36:39], v[116:119], v[92:95], v[36:39]
  ds_read_b64_tr_b16 v[148:149], v11 offset:53248
  ds_read_b64_tr_b16 v[150:151], v11 offset:54272
  v_mfma_f32_16x16x32_bf16 v[56:59], v[92:95], v[120:123], v[56:59]
  ds_read_b128 v[124:127], v9 offset:34816
  ds_read_b64_tr_b16 v[152:153], v11 offset:61440
  v_mfma_f32_16x16x32_bf16 v[40:43], v[116:119], v[96:99], v[40:43]
  ds_read_b64_tr_b16 v[154:155], v11 offset:62464
  ds_read_b64_tr_b16 v[144:145], v10 offset:53248
  v_mfma_f32_16x16x32_bf16 v[60:63], v[96:99], v[120:123], v[60:63]
  ds_read_b64_tr_b16 v[146:147], v10 offset:54272
  ds_read_b128 v[128:131], v9 offset:36864
  v_mfma_f32_16x16x32_bf16 v[76:79], v[112:115], v[96:99], v[76:79]
  ds_read_b128 v[132:135], v9 offset:38912
  ds_read_b128 v[136:139], v9 offset:40960
  v_mfma_f32_16x16x32_bf16 v[44:47], v[116:119], v[100:103], v[44:47]
  ds_read_b128 v[140:143], v9 offset:43008
  v_mfma_f32_16x16x32_bf16 v[64:67], v[100:103], v[120:123], v[64:67]
  v_mfma_f32_16x16x32_bf16 v[80:83], v[112:115], v[100:103], v[80:83]
  v_mfma_f32_16x16x32_bf16 v[48:51], v[116:119], v[104:107], v[48:51]
  v_mfma_f32_16x16x32_bf16 v[68:71], v[104:107], v[120:123], v[68:71]
  v_mfma_f32_16x16x32_bf16 v[84:87], v[112:115], v[104:107], v[84:87]
  v_mfma_f32_16x16x32_bf16 v[52:55], v[116:119], v[108:111], v[52:55]
  v_mfma_f32_16x16x32_bf16 v[72:75], v[108:111], v[120:123], v[72:75]
  v_mfma_f32_16x16x32_bf16 v[88:91], v[112:115], v[108:111], v[88:91]
  s_waitcnt lgkmcnt(0)
  s_barrier
  v_mfma_f32_16x16x32_bf16 v[36:39], v[148:151], v[124:127], v[36:39]
  ds_read_b64_tr_b16 v[116:117], v15 offset:10240
  ds_read_b64_tr_b16 v[118:119], v15 offset:11264
  v_mfma_f32_16x16x32_bf16 v[56:59], v[124:127], v[152:155], v[56:59]
  ds_read_b128 v[92:95], v12 offset:0
  ds_read_b64_tr_b16 v[120:121], v14 offset:26624
  v_mfma_f32_16x16x32_bf16 v[40:43], v[148:151], v[128:131], v[40:43]
  ds_read_b64_tr_b16 v[122:123], v14 offset:27648
  ds_read_b64_tr_b16 v[112:113], v14 offset:10240
  v_mfma_f32_16x16x32_bf16 v[60:63], v[128:131], v[152:155], v[60:63]
  ds_read_b64_tr_b16 v[114:115], v14 offset:11264
  ds_read_b128 v[96:99], v12 offset:2048
  v_mfma_f32_16x16x32_bf16 v[76:79], v[144:147], v[128:131], v[76:79]
  ds_read_b128 v[100:103], v12 offset:4096
  ds_read_b128 v[104:107], v12 offset:6144
  v_mfma_f32_16x16x32_bf16 v[44:47], v[148:151], v[132:135], v[44:47]
  ds_read_b128 v[108:111], v12 offset:8192
  v_mfma_f32_16x16x32_bf16 v[64:67], v[132:135], v[152:155], v[64:67]
  v_mfma_f32_16x16x32_bf16 v[80:83], v[144:147], v[132:135], v[80:83]
  v_mfma_f32_16x16x32_bf16 v[48:51], v[148:151], v[136:139], v[48:51]
  v_mfma_f32_16x16x32_bf16 v[68:71], v[136:139], v[152:155], v[68:71]
  v_mfma_f32_16x16x32_bf16 v[84:87], v[144:147], v[136:139], v[84:87]
  v_mfma_f32_16x16x32_bf16 v[52:55], v[148:151], v[140:143], v[52:55]
  v_mfma_f32_16x16x32_bf16 v[72:75], v[140:143], v[152:155], v[72:75]
  v_mfma_f32_16x16x32_bf16 v[88:91], v[144:147], v[140:143], v[88:91]
  s_waitcnt lgkmcnt(0)
  v_mfma_f32_16x16x32_bf16 v[36:39], v[116:119], v[92:95], v[36:39]
  ds_read_b64_tr_b16 v[148:149], v15 offset:18432
  ds_read_b64_tr_b16 v[150:151], v15 offset:19456
  v_mfma_f32_16x16x32_bf16 v[56:59], v[92:95], v[120:123], v[56:59]
  ds_read_b128 v[124:127], v13 offset:0
  ds_read_b64_tr_b16 v[152:153], v15 offset:26624
  v_mfma_f32_16x16x32_bf16 v[40:43], v[116:119], v[96:99], v[40:43]
  ds_read_b64_tr_b16 v[154:155], v15 offset:27648
  ds_read_b64_tr_b16 v[144:145], v14 offset:18432
  v_mfma_f32_16x16x32_bf16 v[60:63], v[96:99], v[120:123], v[60:63]
  ds_read_b64_tr_b16 v[146:147], v14 offset:19456
  ds_read_b128 v[128:131], v13 offset:2048
  v_mfma_f32_16x16x32_bf16 v[76:79], v[112:115], v[96:99], v[76:79]
  ds_read_b128 v[132:135], v13 offset:4096
  ds_read_b128 v[136:139], v13 offset:6144
  v_mfma_f32_16x16x32_bf16 v[44:47], v[116:119], v[100:103], v[44:47]
  ds_read_b128 v[140:143], v13 offset:8192
  v_mfma_f32_16x16x32_bf16 v[64:67], v[100:103], v[120:123], v[64:67]
  v_mfma_f32_16x16x32_bf16 v[80:83], v[112:115], v[100:103], v[80:83]
  v_mfma_f32_16x16x32_bf16 v[48:51], v[116:119], v[104:107], v[48:51]
  v_mfma_f32_16x16x32_bf16 v[68:71], v[104:107], v[120:123], v[68:71]
  v_mfma_f32_16x16x32_bf16 v[84:87], v[112:115], v[104:107], v[84:87]
  v_mfma_f32_16x16x32_bf16 v[52:55], v[116:119], v[108:111], v[52:55]
  v_mfma_f32_16x16x32_bf16 v[72:75], v[108:111], v[120:123], v[72:75]
  v_mfma_f32_16x16x32_bf16 v[88:91], v[112:115], v[108:111], v[88:91]
  s_waitcnt lgkmcnt(0)
  s_barrier
  v_mfma_f32_16x16x32_bf16 v[36:39], v[148:151], v[124:127], v[36:39]
  ds_read_b64_tr_b16 v[116:117], v15 offset:45056
  ds_read_b64_tr_b16 v[118:119], v15 offset:46080
  v_mfma_f32_16x16x32_bf16 v[56:59], v[124:127], v[152:155], v[56:59]
  ds_read_b128 v[92:95], v12 offset:34816
  ds_read_b64_tr_b16 v[120:121], v14 offset:61440
  v_mfma_f32_16x16x32_bf16 v[40:43], v[148:151], v[128:131], v[40:43]
  ds_read_b64_tr_b16 v[122:123], v14 offset:62464
  ds_read_b64_tr_b16 v[112:113], v14 offset:45056
  v_mfma_f32_16x16x32_bf16 v[60:63], v[128:131], v[152:155], v[60:63]
  ds_read_b64_tr_b16 v[114:115], v14 offset:46080
  ds_read_b128 v[96:99], v12 offset:36864
  v_mfma_f32_16x16x32_bf16 v[76:79], v[144:147], v[128:131], v[76:79]
  ds_read_b128 v[100:103], v12 offset:38912
  ds_read_b128 v[104:107], v12 offset:40960
  v_mfma_f32_16x16x32_bf16 v[44:47], v[148:151], v[132:135], v[44:47]
  ds_read_b128 v[108:111], v12 offset:43008
  v_mfma_f32_16x16x32_bf16 v[64:67], v[132:135], v[152:155], v[64:67]
  v_mfma_f32_16x16x32_bf16 v[80:83], v[144:147], v[132:135], v[80:83]
  v_mfma_f32_16x16x32_bf16 v[48:51], v[148:151], v[136:139], v[48:51]
  v_mfma_f32_16x16x32_bf16 v[68:71], v[136:139], v[152:155], v[68:71]
  v_mfma_f32_16x16x32_bf16 v[84:87], v[144:147], v[136:139], v[84:87]
  v_mfma_f32_16x16x32_bf16 v[52:55], v[148:151], v[140:143], v[52:55]
  v_mfma_f32_16x16x32_bf16 v[72:75], v[140:143], v[152:155], v[72:75]
  v_mfma_f32_16x16x32_bf16 v[88:91], v[144:147], v[140:143], v[88:91]
  s_waitcnt lgkmcnt(0)
  v_mfma_f32_16x16x32_bf16 v[36:39], v[116:119], v[92:95], v[36:39]
  ds_read_b64_tr_b16 v[148:149], v15 offset:53248
  ds_read_b64_tr_b16 v[150:151], v15 offset:54272
  v_mfma_f32_16x16x32_bf16 v[56:59], v[92:95], v[120:123], v[56:59]
  ds_read_b128 v[124:127], v13 offset:34816
  ds_read_b64_tr_b16 v[152:153], v15 offset:61440
  v_mfma_f32_16x16x32_bf16 v[40:43], v[116:119], v[96:99], v[40:43]
  ds_read_b64_tr_b16 v[154:155], v15 offset:62464
  ds_read_b64_tr_b16 v[144:145], v14 offset:53248
  v_mfma_f32_16x16x32_bf16 v[60:63], v[96:99], v[120:123], v[60:63]
  ds_read_b64_tr_b16 v[146:147], v14 offset:54272
  ds_read_b128 v[128:131], v13 offset:36864
  v_mfma_f32_16x16x32_bf16 v[76:79], v[112:115], v[96:99], v[76:79]
  ds_read_b128 v[132:135], v13 offset:38912
  ds_read_b128 v[136:139], v13 offset:40960
  v_mfma_f32_16x16x32_bf16 v[44:47], v[116:119], v[100:103], v[44:47]
  ds_read_b128 v[140:143], v13 offset:43008
  v_mfma_f32_16x16x32_bf16 v[64:67], v[100:103], v[120:123], v[64:67]
  v_mfma_f32_16x16x32_bf16 v[80:83], v[112:115], v[100:103], v[80:83]
  v_mfma_f32_16x16x32_bf16 v[48:51], v[116:119], v[104:107], v[48:51]
  v_mfma_f32_16x16x32_bf16 v[68:71], v[104:107], v[120:123], v[68:71]
  v_mfma_f32_16x16x32_bf16 v[84:87], v[112:115], v[104:107], v[84:87]
  v_mfma_f32_16x16x32_bf16 v[52:55], v[116:119], v[108:111], v[52:55]
  v_mfma_f32_16x16x32_bf16 v[72:75], v[108:111], v[120:123], v[72:75]
  v_mfma_f32_16x16x32_bf16 v[88:91], v[112:115], v[108:111], v[88:91]
  s_waitcnt lgkmcnt(0)
  v_mfma_f32_16x16x32_bf16 v[36:39], v[148:151], v[124:127], v[36:39]
  v_mfma_f32_16x16x32_bf16 v[56:59], v[124:127], v[152:155], v[56:59]
  v_mfma_f32_16x16x32_bf16 v[40:43], v[148:151], v[128:131], v[40:43]
  v_mfma_f32_16x16x32_bf16 v[60:63], v[128:131], v[152:155], v[60:63]
  v_mfma_f32_16x16x32_bf16 v[76:79], v[144:147], v[128:131], v[76:79]
  v_mfma_f32_16x16x32_bf16 v[44:47], v[148:151], v[132:135], v[44:47]
  v_mfma_f32_16x16x32_bf16 v[64:67], v[132:135], v[152:155], v[64:67]
  v_mfma_f32_16x16x32_bf16 v[80:83], v[144:147], v[132:135], v[80:83]
  v_mfma_f32_16x16x32_bf16 v[48:51], v[148:151], v[136:139], v[48:51]
  v_mfma_f32_16x16x32_bf16 v[68:71], v[136:139], v[152:155], v[68:71]
  v_mfma_f32_16x16x32_bf16 v[84:87], v[144:147], v[136:139], v[84:87]
  v_mfma_f32_16x16x32_bf16 v[52:55], v[148:151], v[140:143], v[52:55]
  v_mfma_f32_16x16x32_bf16 v[72:75], v[140:143], v[152:155], v[72:75]
  v_mfma_f32_16x16x32_bf16 v[88:91], v[144:147], v[140:143], v[88:91]
  v_cvt_pk_bf16_f32 v100, v36, v37
  v_cvt_pk_bf16_f32 v101, v38, v39
  v_cvt_pk_bf16_f32 v102, v40, v41
  v_cvt_pk_bf16_f32 v103, v42, v43
  v_cvt_pk_bf16_f32 v92, v76, v77
  v_cvt_pk_bf16_f32 v93, v78, v79
  v_cvt_pk_bf16_f32 v104, v44, v45
  v_cvt_pk_bf16_f32 v105, v46, v47
  v_cvt_pk_bf16_f32 v94, v80, v81
  v_cvt_pk_bf16_f32 v95, v82, v83
  v_cvt_pk_bf16_f32 v106, v48, v49
  v_cvt_pk_bf16_f32 v107, v50, v51
  v_cvt_pk_bf16_f32 v96, v84, v85
  v_cvt_pk_bf16_f32 v97, v86, v87
  v_cvt_pk_bf16_f32 v108, v52, v53
  v_cvt_pk_bf16_f32 v109, v54, v55
  v_cvt_pk_bf16_f32 v98, v88, v89
  v_cvt_pk_bf16_f32 v99, v90, v91
  v_mfma_f32_16x16x16_bf16 v[136:139], v[100:101], v[92:93], 0
  v_mfma_f32_16x16x16_bf16 v[120:123], v[102:103], v[92:93], 0
  v_mfma_f32_16x16x16_bf16 v[140:143], v[102:103], v[94:95], 0
  v_mfma_f32_16x16x16_bf16 v[124:127], v[104:105], v[94:95], 0
  v_mfma_f32_16x16x16_bf16 v[144:147], v[104:105], v[96:97], 0
  v_mfma_f32_16x16x16_bf16 v[128:131], v[106:107], v[96:97], 0
  v_mfma_f32_16x16x16_bf16 v[148:151], v[106:107], v[98:99], 0
  v_mfma_f32_16x16x16_bf16 v[132:135], v[108:109], v[98:99], 0
  v_cvt_pk_bf16_f32 v110, v56, v57
  v_cvt_pk_bf16_f32 v111, v58, v59
  v_cvt_pk_bf16_f32 v112, v60, v61
  v_cvt_pk_bf16_f32 v113, v62, v63
  v_cvt_pk_bf16_f32 v114, v64, v65
  v_cvt_pk_bf16_f32 v115, v66, v67
  v_cvt_pk_bf16_f32 v116, v68, v69
  v_cvt_pk_bf16_f32 v117, v70, v71
  v_cvt_pk_bf16_f32 v118, v72, v73
  v_cvt_pk_bf16_f32 v119, v74, v75
  s_cmp_lg_u32 s25, 0
  s_cbranch_scc1 K1_NOMASK
  v_mov_b32 v136, 0xff800000
  v_mov_b32 v137, 0xff800000
  v_mov_b32 v138, 0xff800000
  v_mov_b32 v139, 0xff800000
K1_NOMASK:
  v_cndmask_b32 v120, v136, v120, s[48:49]
  v_cndmask_b32 v121, v137, v121, s[50:51]
  v_cndmask_b32 v122, v138, v122, s[52:53]
  v_cndmask_b32 v123, v139, v123, s[54:55]
  v_cndmask_b32 v124, v140, v124, s[48:49]
  v_cndmask_b32 v125, v141, v125, s[50:51]
  v_cndmask_b32 v126, v142, v126, s[52:53]
  v_cndmask_b32 v127, v143, v127, s[54:55]
  v_cndmask_b32 v128, v144, v128, s[48:49]
  v_cndmask_b32 v129, v145, v129, s[50:51]
  v_cndmask_b32 v130, v146, v130, s[52:53]
  v_cndmask_b32 v131, v147, v131, s[54:55]
  v_cndmask_b32 v132, v148, v132, s[48:49]
  v_cndmask_b32 v133, v149, v133, s[50:51]
  v_cndmask_b32 v134, v150, v134, s[52:53]
  v_cndmask_b32 v135, v151, v135, s[54:55]
  v_cndmask_b32 v152, v120, v121, s[56:57]
  v_cndmask_b32 v156, v122, v123, s[56:57]
  v_cndmask_b32 v153, v124, v125, s[56:57]
  v_cndmask_b32 v157, v126, v127, s[56:57]
  v_cndmask_b32 v154, v128, v129, s[56:57]
  v_cndmask_b32 v158, v130, v131, s[56:57]
  v_cndmask_b32 v155, v132, v133, s[56:57]
  v_cndmask_b32 v159, v134, v135, s[56:57]
  v_cvt_pk_bf16_f32 v164, v152, v156
  v_cvt_pk_bf16_f32 v165, v153, v157
  v_cvt_pk_bf16_f32 v166, v154, v158
  v_cvt_pk_bf16_f32 v167, v155, v159
  v_lshlrev_b32 v152, 16, v164
  v_and_b32 v156, 0xffff0000, v164
  v_lshlrev_b32 v153, 16, v165
  v_and_b32 v157, 0xffff0000, v165
  v_lshlrev_b32 v154, 16, v166
  v_and_b32 v158, 0xffff0000, v166
  v_lshlrev_b32 v155, 16, v167
  v_and_b32 v159, 0xffff0000, v167
  v_max_f32 v160, v152, v156
  v_max_f32 v161, v153, v157
  v_max_f32 v162, v154, v158
  v_max_f32 v163, v155, v159
  v_mov_b32 v164, v160
  v_mov_b32 v165, v161
  v_mov_b32 v166, v162
  v_mov_b32 v167, v163
  v_permlane32_swap_b32 v160, v164
  v_permlane32_swap_b32 v161, v165
  v_permlane32_swap_b32 v162, v166
  v_permlane32_swap_b32 v163, v167
  v_max_f32 v160, v160, v164
  v_max_f32 v161, v161, v165
  v_max_f32 v162, v162, v166
  v_max_f32 v163, v163, v167
  v_mov_b32 v164, v160
  v_mov_b32 v165, v161
  v_mov_b32 v166, v162
  v_mov_b32 v167, v163
  v_permlane16_swap_b32 v160, v164
  v_permlane16_swap_b32 v161, v165
  v_permlane16_swap_b32 v162, v166
  v_permlane16_swap_b32 v163, v167
  v_max_f32 v160, v160, v164
  v_max_f32 v161, v161, v165
  v_max_f32 v162, v162, v166
  v_max_f32 v163, v163, v167
  s_mov_b32 s34, 0x3eb8aa3b
  v_sub_f32 v152, v152, v160
  v_sub_f32 v156, v156, v160
  v_sub_f32 v153, v153, v161
  v_sub_f32 v157, v157, v161
  v_sub_f32 v154, v154, v162
  v_sub_f32 v158, v158, v162
  v_sub_f32 v155, v155, v163
  v_sub_f32 v159, v159, v163
  v_mul_f32 v152, s34, v152
  v_mul_f32 v156, s34, v156
  v_mul_f32 v153, s34, v153
  v_mul_f32 v157, s34, v157
  v_mul_f32 v154, s34, v154
  v_mul_f32 v158, s34, v158
  v_mul_f32 v155, s34, v155
  v_mul_f32 v159, s34, v159
  v_exp_f32 v152, v152
  v_exp_f32 v156, v156
  v_exp_f32 v153, v153
  v_exp_f32 v157, v157
  v_exp_f32 v154, v154
  v_exp_f32 v158, v158
  v_exp_f32 v155, v155
  v_exp_f32 v159, v159
  v_add_f32 v168, v152, v156
  v_add_f32 v169, v153, v157
  v_add_f32 v170, v154, v158
  v_add_f32 v171, v155, v159
  v_mov_b32 v164, v168
  v_mov_b32 v165, v169
  v_mov_b32 v166, v170
  v_mov_b32 v167, v171
  v_permlane32_swap_b32 v168, v164
  v_permlane32_swap_b32 v169, v165
  v_permlane32_swap_b32 v170, v166
  v_permlane32_swap_b32 v171, v167
  v_add_f32 v168, v168, v164
  v_add_f32 v169, v169, v165
  v_add_f32 v170, v170, v166
  v_add_f32 v171, v171, v167
  v_mov_b32 v164, v168
  v_mov_b32 v165, v169
  v_mov_b32 v166, v170
  v_mov_b32 v167, v171
  v_permlane16_swap_b32 v168, v164
  v_permlane16_swap_b32 v169, v165
  v_permlane16_swap_b32 v170, v166
  v_permlane16_swap_b32 v171, v167
  v_add_f32 v168, v168, v164
  v_add_f32 v169, v169, v165
  v_add_f32 v170, v170, v166
  v_add_f32 v171, v171, v167
  v_rcp_f32 v168, v168
  v_rcp_f32 v169, v169
  v_rcp_f32 v170, v170
  v_rcp_f32 v171, v171
  v_mul_f32 v152, v152, v168
  v_mul_f32 v156, v156, v168
  v_mul_f32 v153, v153, v169
  v_mul_f32 v157, v157, v169
  v_mul_f32 v154, v154, v170
  v_mul_f32 v158, v158, v170
  v_mul_f32 v155, v155, v171
  v_mul_f32 v159, v159, v171
  v_cvt_pk_bf16_f32 v152, v152, v152
  v_cvt_pk_bf16_f32 v156, v156, v156
  v_cvt_pk_bf16_f32 v153, v153, v153
  v_cvt_pk_bf16_f32 v157, v157, v157
  v_cvt_pk_bf16_f32 v154, v154, v154
  v_cvt_pk_bf16_f32 v158, v158, v158
  v_cvt_pk_bf16_f32 v155, v155, v155
  v_cvt_pk_bf16_f32 v159, v159, v159
  v_and_b32 v20, v152, v18
  v_and_b32 v21, v156, v19
  v_and_b32 v22, v152, v16
  v_and_b32 v23, v156, v17
  v_and_b32 v24, v153, v18
  v_and_b32 v25, v157, v19
  v_and_b32 v26, v153, v16
  v_and_b32 v27, v157, v17
  v_and_b32 v28, v154, v18
  v_and_b32 v29, v158, v19
  v_and_b32 v30, v154, v16
  v_and_b32 v31, v158, v17
  v_and_b32 v32, v155, v18
  v_and_b32 v33, v159, v19
  v_and_b32 v34, v155, v16
  v_and_b32 v35, v159, v17
  v_mfma_f32_16x16x32_bf16 v[120:123], v[110:113], v[20:23], 0
  v_mfma_f32_16x16x32_bf16 v[124:127], v[112:115], v[24:27], 0
  v_mfma_f32_16x16x32_bf16 v[128:131], v[114:117], v[28:31], 0
  v_mfma_f32_16x16x32_bf16 v[132:135], v[116:119], v[32:35], 0
  s_nop 4
  v_cvt_pk_bf16_f32 v136, v120, v121
  v_cvt_pk_bf16_f32 v137, v122, v123
  v_cvt_pk_bf16_f32 v138, v124, v125
  v_cvt_pk_bf16_f32 v139, v126, v127
  v_cvt_pk_bf16_f32 v140, v128, v129
  v_cvt_pk_bf16_f32 v141, v130, v131
  v_cvt_pk_bf16_f32 v142, v132, v133
  v_cvt_pk_bf16_f32 v143, v134, v135
  v_permlane16_swap_b32 v136, v138
  v_permlane16_swap_b32 v137, v139
  v_permlane16_swap_b32 v140, v142
  v_permlane16_swap_b32 v141, v143
  buffer_store_dwordx4 v[136:139], v3, s[20:23], s47 offen
  buffer_store_dwordx4 v[140:143], v3, s[20:23], s45 offen
K1_END:
  s_endpgm
.globl fn_stage2_kernel
.p2align 8
.type fn_stage2_kernel,@function
fn_stage2_kernel:
  s_cmp_ge_u32 s2, 256
  s_cbranch_scc1 K2_END
  s_load_dwordx2 s[8:9], s[0:1], 56
  s_load_dwordx2 s[20:21], s[0:1], 80
  s_load_dwordx2 s[12:13], s[0:1], 64
  v_lshrrev_b32 v3, 6, v0
  v_and_b32 v0, 63, v0
  v_readfirstlane_b32 s24, v3
  s_mov_b32 s10, 0x80000
  s_mov_b32 s11, 0x20000
  s_mov_b32 s22, 7340032
  s_mov_b32 s23, 0x20000
  s_and_b32 s32, s2, 7
  s_lshr_b32 s33, s2, 3
  s_and_b32 s30, s24, 3
  s_lshr_b32 s31, s24, 2
  v_and_b32 v1, 15, v0
  v_lshrrev_b32 v2, 4, v0
  v_lshlrev_b32 v7, 4, v0
  s_lshr_b32 s34, s32, 1
  s_lshl_b32 s34, s34, 3
  s_lshr_b32 s35, s33, 2
  s_add_u32 s25, s34, s35
  s_and_b32 s34, s32, 1
  s_lshl_b32 s34, s34, 2
  s_and_b32 s35, s33, 3
  s_add_u32 s26, s34, s35
  s_lshl_b32 s34, s24, 2
  v_add_u32 v3, s34, v2
  s_and_b32 s34, s34, 8
  v_lshl_add_u32 v4, v2, 1, s34
  v_xor_b32 v4, v1, v4
  v_and_b32 v5, 7, v4
  v_lshlrev_b32 v5, 4, v5
  v_lshl_add_u32 v5, v3, 10, v5
  v_lshrrev_b32 v4, 3, v4
  v_lshl_add_u32 v8, v4, 18, v5
  s_lshl_b32 s35, s26, 7
  s_lshl_b32 m0, s24, 10
  s_lshl_b32 s36, s25, 2
  s_add_u32 s36, s36, s30
  s_lshl_b32 s36, s36, 14
  s_lshl_b32 s34, s31, 13
  s_add_u32 s36, s36, s34
  s_add_u32 s37, s36, 4096
  s_waitcnt lgkmcnt(0)
  s_add_u32 s38, s25, s26
  s_lshl_b32 s41, s24, 10
  s_add_u32 m0, s41, 0
  s_and_b32 s38, s38, 7
  s_lshl_b32 s39, s38, 15
  s_add_u32 s39, s39, s35
  s_lshl_b32 s40, s38, 10
  s_add_u32 s40, s40, s36
  buffer_load_dwordx4 v8, s[8:11], s39 offen lds
  buffer_load_dwordx4 v[72:75], v7, s[20:23], s40 offen
  s_add_u32 s38, s38, 1
  s_lshl_b32 s41, s24, 10
  s_add_u32 m0, s41, 8192
  s_and_b32 s38, s38, 7
  s_lshl_b32 s39, s38, 15
  s_add_u32 s39, s39, s35
  s_lshl_b32 s40, s38, 10
  s_add_u32 s40, s40, s36
  buffer_load_dwordx4 v8, s[8:11], s39 offen lds
  buffer_load_dwordx4 v[76:79], v7, s[20:23], s40 offen
  s_add_u32 s38, s38, 1
  s_lshl_b32 s34, s32, 5
  s_add_u32 s34, s34, s33
  s_and_b32 s28, s34, 1
  s_bfe_u32 s29, s34, 0x30001
  s_lshr_b32 s27, s34, 4
  v_lshlrev_b32 v3, 2, v2
  v_xor_b32 v3, v1, v3
  v_and_b32 v4, 7, v3
  v_lshlrev_b32 v4, 4, v4
  v_lshrrev_b32 v3, 3, v3
  v_lshl_add_u32 v4, v3, 10, v4
  v_lshl_add_u32 v9, v2, 11, v4
  s_lshl_b32 s42, s27, 18
  s_lshl_b32 s34, s24, 15
  s_add_u32 s42, s42, s34
  s_lshl_b32 s34, s29, 7
  s_add_u32 s42, s42, s34
  s_add_u32 s42, s42, 2097152
  s_lshl_b32 s34, s24, 12
  s_add_u32 m0, s34, 65536
  s_mov_b32 s14, 0x400000
  s_mov_b32 s15, 0x20000
  buffer_load_dwordx4 v9, s[20:23], s42 offen lds
  s_add_u32 m0, m0, 1024
  s_add_u32 s42, s42, 8192
  buffer_load_dwordx4 v9, s[20:23], s42 offen lds
  s_add_u32 m0, m0, 1024
  s_add_u32 s42, s42, 8192
  buffer_load_dwordx4 v9, s[20:23], s42 offen lds
  s_add_u32 m0, m0, 1024
  s_add_u32 s42, s42, 8192
  buffer_load_dwordx4 v9, s[20:23], s42 offen lds
  s_lshl_b32 s41, s24, 10
  s_add_u32 m0, s41, 16384
  s_and_b32 s38, s38, 7
  s_lshl_b32 s39, s38, 15
  s_add_u32 s39, s39, s35
  s_lshl_b32 s40, s38, 10
  s_add_u32 s40, s40, s36
  buffer_load_dwordx4 v8, s[8:11], s39 offen lds
  buffer_load_dwordx4 v[80:83], v7, s[20:23], s40 offen
  s_add_u32 s38, s38, 1
  s_lshl_b32 s41, s24, 10
  s_add_u32 m0, s41, 24576
  s_and_b32 s38, s38, 7
  s_lshl_b32 s39, s38, 15
  s_add_u32 s39, s39, s35
  s_lshl_b32 s40, s38, 10
  s_add_u32 s40, s40, s36
  buffer_load_dwordx4 v8, s[8:11], s39 offen lds
  buffer_load_dwordx4 v[84:87], v7, s[20:23], s40 offen
  s_add_u32 s38, s38, 1
  s_lshl_b32 s41, s24, 10
  s_add_u32 m0, s41, 32768
  s_and_b32 s38, s38, 7
  s_lshl_b32 s39, s38, 15
  s_add_u32 s39, s39, s35
  s_lshl_b32 s40, s38, 10
  s_add_u32 s40, s40, s36
  buffer_load_dwordx4 v8, s[8:11], s39 offen lds
  buffer_load_dwordx4 v[88:91], v7, s[20:23], s40 offen
  s_add_u32 s38, s38, 1
  s_lshl_b32 s41, s24, 10
  s_add_u32 m0, s41, 40960
  s_and_b32 s38, s38, 7
  s_lshl_b32 s39, s38, 15
  s_add_u32 s39, s39, s35
  s_lshl_b32 s40, s38, 10
  s_add_u32 s40, s40, s36
  buffer_load_dwordx4 v8, s[8:11], s39 offen lds
  buffer_load_dwordx4 v[92:95], v7, s[20:23], s40 offen
  s_add_u32 s38, s38, 1
  s_lshl_b32 s41, s24, 10
  s_add_u32 m0, s41, 49152
  s_and_b32 s38, s38, 7
  s_lshl_b32 s39, s38, 15
  s_add_u32 s39, s39, s35
  s_lshl_b32 s40, s38, 10
  s_add_u32 s40, s40, s36
  buffer_load_dwordx4 v8, s[8:11], s39 offen lds
  buffer_load_dwordx4 v[96:99], v7, s[20:23], s40 offen
  s_add_u32 s38, s38, 1
  s_lshl_b32 s41, s24, 10
  s_add_u32 m0, s41, 57344
  s_and_b32 s38, s38, 7
  s_lshl_b32 s39, s38, 15
  s_add_u32 s39, s39, s35
  s_lshl_b32 s40, s38, 10
  s_add_u32 s40, s40, s36
  buffer_load_dwordx4 v8, s[8:11], s39 offen lds
  buffer_load_dwordx4 v[100:103], v7, s[20:23], s40 offen
  s_add_u32 s38, s38, 1
  v_bfe_u32 v3, v0, 2, 2
  v_and_b32 v4, 3, v0
  v_lshl_add_u32 v5, v2, 3, v3
  v_lshlrev_b32 v5, 8, v5
  v_lshrrev_b32 v6, 1, v4
  v_lshlrev_b32 v136, 1, v3
  v_xor_b32 v6, v6, v136
  v_and_b32 v136, 1, v2
  v_lshlrev_b32 v137, 3, v136
  v_xor_b32 v6, v6, v137
  v_lshl_add_u32 v5, v6, 4, v5
  v_and_b32 v6, 1, v4
  v_lshl_add_u32 v5, v6, 3, v5
  s_mul_i32 s34, s31, 192
  v_xor_b32 v12, s34, v5
  v_xor_b32 v13, 32, v12
  v_xor_b32 v14, 64, v12
  v_xor_b32 v15, 96, v12
  v_lshl_add_u32 v5, v2, 2, v3
  v_lshlrev_b32 v5, 8, v5
  v_lshlrev_b32 v6, 2, v3
  v_xor_b32 v6, v6, v4
  v_lshl_add_u32 v5, v6, 4, v5
  v_add_u32 v5, v5, v137
  s_lshl_b32 s34, s31, 6
  v_xor_b32 v5, s34, v5
  s_lshl_b32 s34, s31, 14
  s_add_u32 s34, s34, 65536
  v_add_u32 v16, s34, v5
  v_xor_b32 v17, 8, v16
  v_xor_b32 v18, 128, v16
  v_xor_b32 v19, 136, v16
  v_xor_b32 v20, 64, v16
  v_xor_b32 v21, 72, v16
  v_xor_b32 v22, 192, v16
  v_xor_b32 v23, 200, v16
  s_lshl_b32 s34, s28, 6
  s_lshl_b32 s35, s30, 4
  s_add_u32 s34, s34, s35
  v_add_u32 v3, s34, v1
  v_lshlrev_b32 v3, 4, v3
  v_add_u32 v10, s27, v3
  v_cvt_f32_u32 v3, v10
  v_mul_f32 v3, 0x3a000000, v3
  v_mul_f32 v4, 0x41800000, v3
  v_and_b32 v5, 1, v2
  v_cvt_f32_u32 v5, v5
  v_mul_f32 v5, 0x3e800000, v5
  s_lshl_b32 s34, s31, 6
  v_lshl_add_u32 v6, v2, 2, s34
  v_cvt_f32_u32 v6, v6
  v_mul_f32 v144, v6, v3
  v_fmamk_f32 v145, v3, 0x3f800000, v144
  v_fmamk_f32 v146, v3, 0x40000000, v144
  v_fmamk_f32 v147, v3, 0x40400000, v144
  v_sub_f32 v136, v144, v5
  v_add_f32 v140, v144, v5
  v_sub_f32 v137, v145, v5
  v_add_f32 v141, v145, v5
  v_sub_f32 v138, v146, v5
  v_add_f32 v142, v146, v5
  v_sub_f32 v139, v147, v5
  v_add_f32 v143, v147, v5
  v_cos_f32 v144, v136
  v_sin_f32 v148, v140
  v_cos_f32 v145, v137
  v_sin_f32 v149, v141
  v_cos_f32 v146, v138
  v_sin_f32 v150, v142
  v_cos_f32 v147, v139
  v_sin_f32 v151, v143
  v_add_f32 v136, v136, v4
  v_add_f32 v140, v140, v4
  v_add_f32 v137, v137, v4
  v_add_f32 v141, v141, v4
  v_add_f32 v138, v138, v4
  v_add_f32 v142, v142, v4
  v_add_f32 v139, v139, v4
  v_add_f32 v143, v143, v4
  v_cvt_pk_bf16_f32 v24, v144, v145
  v_cvt_pk_bf16_f32 v25, v146, v147
  v_cvt_pk_bf16_f32 v26, v148, v149
  v_cvt_pk_bf16_f32 v27, v150, v151
  v_cos_f32 v144, v136
  v_sin_f32 v148, v140
  v_cos_f32 v145, v137
  v_sin_f32 v149, v141
  v_cos_f32 v146, v138
  v_sin_f32 v150, v142
  v_cos_f32 v147, v139
  v_sin_f32 v151, v143
  v_add_f32 v136, v136, v4
  v_add_f32 v140, v140, v4
  v_add_f32 v137, v137, v4
  v_add_f32 v141, v141, v4
  v_add_f32 v138, v138, v4
  v_add_f32 v142, v142, v4
  v_add_f32 v139, v139, v4
  v_add_f32 v143, v143, v4
  v_cvt_pk_bf16_f32 v28, v144, v145
  v_cvt_pk_bf16_f32 v29, v146, v147
  v_cvt_pk_bf16_f32 v30, v148, v149
  v_cvt_pk_bf16_f32 v31, v150, v151
  v_cos_f32 v144, v136
  v_sin_f32 v148, v140
  v_cos_f32 v145, v137
  v_sin_f32 v149, v141
  v_cos_f32 v146, v138
  v_sin_f32 v150, v142
  v_cos_f32 v147, v139
  v_sin_f32 v151, v143
  v_add_f32 v136, v136, v4
  v_add_f32 v140, v140, v4
  v_add_f32 v137, v137, v4
  v_add_f32 v141, v141, v4
  v_add_f32 v138, v138, v4
  v_add_f32 v142, v142, v4
  v_add_f32 v139, v139, v4
  v_add_f32 v143, v143, v4
  v_cvt_pk_bf16_f32 v32, v144, v145
  v_cvt_pk_bf16_f32 v33, v146, v147
  v_cvt_pk_bf16_f32 v34, v148, v149
  v_cvt_pk_bf16_f32 v35, v150, v151
  v_cos_f32 v144, v136
  v_sin_f32 v148, v140
  v_cos_f32 v145, v137
  v_sin_f32 v149, v141
  v_cos_f32 v146, v138
  v_sin_f32 v150, v142
  v_cos_f32 v147, v139
  v_sin_f32 v151, v143
  v_cvt_pk_bf16_f32 v36, v144, v145
  v_cvt_pk_bf16_f32 v37, v146, v147
  v_cvt_pk_bf16_f32 v38, v148, v149
  v_cvt_pk_bf16_f32 v39, v150, v151
  s_lshl_b32 s34, s24, 12
  s_add_u32 s34, s34, 98304
  v_add_u32 v4, s34, v7
  v_xor_b32 v5, 0x4000, v4
  v_and_b32 v3, 1, v2
  v_lshlrev_b32 v3, 5, v3
  v_lshrrev_b32 v6, 1, v2
  v_lshl_add_u32 v3, v6, 4, v3
  v_lshl_add_u32 v10, v10, 11, v3
  v_lshl_add_u32 v3, v1, 11, v3
  s_lshl_b32 s36, s31, 6
  s_lshl_b32 s34, s29, 7
  s_add_u32 s34, s34, s36
  s_lshl_b32 s35, s25, 2
  s_add_u32 s35, s35, s30
  s_lshl_b32 s35, s35, 15
  s_lshl_b32 s37, s26, 7
  s_add_u32 s35, s35, s37
  s_add_u32 s35, s35, s36
  s_add_u32 s35, s35, 1024
  s_waitcnt vmcnt(16)
  s_barrier
  ds_read_b64_tr_b16 v[104:105], v12 offset:0
  ds_read_b64_tr_b16 v[106:107], v12 offset:1024
  ds_read_b64_tr_b16 v[108:109], v13 offset:0
  ds_read_b64_tr_b16 v[110:111], v13 offset:1024
  ds_read_b64_tr_b16 v[112:113], v14 offset:0
  ds_read_b64_tr_b16 v[114:115], v14 offset:1024
  ds_read_b64_tr_b16 v[116:117], v15 offset:0
  ds_read_b64_tr_b16 v[118:119], v15 offset:1024
  s_waitcnt lgkmcnt(2)
  ds_read_b64_tr_b16 v[120:121], v12 offset:8192
  ds_read_b64_tr_b16 v[122:123], v12 offset:9216
  ds_read_b64_tr_b16 v[124:125], v13 offset:8192
  ds_read_b64_tr_b16 v[126:127], v13 offset:9216
  ds_read_b64_tr_b16 v[128:129], v14 offset:8192
  ds_read_b64_tr_b16 v[130:131], v14 offset:9216
  ds_read_b64_tr_b16 v[132:133], v15 offset:8192
  ds_read_b64_tr_b16 v[134:135], v15 offset:9216
  s_waitcnt lgkmcnt(8)
  v_mfma_f32_16x16x32_bf16 v[48:51], v[112:115], v[72:75], 0
  v_mfma_f32_16x16x32_bf16 v[52:55], v[116:119], v[72:75], 0
  v_mfma_f32_16x16x32_bf16 v[40:43], v[104:107], v[72:75], 0
  v_mfma_f32_16x16x32_bf16 v[44:47], v[108:111], v[72:75], 0
  s_waitcnt lgkmcnt(0)
  v_mfma_f32_16x16x32_bf16 v[48:51], v[128:131], v[76:79], v[48:51]
  v_mfma_f32_16x16x32_bf16 v[52:55], v[132:135], v[76:79], v[52:55]
  v_mfma_f32_16x16x32_bf16 v[40:43], v[120:123], v[76:79], v[40:43]
  v_mfma_f32_16x16x32_bf16 v[44:47], v[124:127], v[76:79], v[44:47]
  s_waitcnt vmcnt(12)
  s_barrier
  ds_read_b64_tr_b16 v[104:105], v16 offset:0
  ds_read_b64_tr_b16 v[106:107], v17 offset:0
  ds_read_b64_tr_b16 v[108:109], v18 offset:0
  ds_read_b64_tr_b16 v[110:111], v19 offset:0
  ds_read_b64_tr_b16 v[112:113], v20 offset:0
  ds_read_b64_tr_b16 v[114:115], v21 offset:0
  ds_read_b64_tr_b16 v[116:117], v22 offset:0
  ds_read_b64_tr_b16 v[118:119], v23 offset:0
  s_waitcnt lgkmcnt(4)
  ds_read_b64_tr_b16 v[120:121], v16 offset:4096
  ds_read_b64_tr_b16 v[122:123], v17 offset:4096
  ds_read_b64_tr_b16 v[124:125], v18 offset:4096
  ds_read_b64_tr_b16 v[126:127], v19 offset:4096
  ds_read_b64_tr_b16 v[128:129], v20 offset:4096
  ds_read_b64_tr_b16 v[130:131], v21 offset:4096
  ds_read_b64_tr_b16 v[132:133], v22 offset:4096
  ds_read_b64_tr_b16 v[134:135], v23 offset:4096
  s_waitcnt lgkmcnt(8)
  v_mfma_f32_16x16x32_bf16 v[64:67], v[112:115], v[24:27], 0
  v_mfma_f32_16x16x32_bf16 v[68:71], v[116:119], v[24:27], 0
  v_mfma_f32_16x16x32_bf16 v[56:59], v[104:107], v[24:27], 0
  v_mfma_f32_16x16x32_bf16 v[60:63], v[108:111], v[24:27], 0
  s_waitcnt lgkmcnt(4)
  ds_read_b64_tr_b16 v[104:105], v16 offset:8192
  ds_read_b64_tr_b16 v[106:107], v17 offset:8192
  ds_read_b64_tr_b16 v[108:109], v18 offset:8192
  ds_read_b64_tr_b16 v[110:111], v19 offset:8192
  ds_read_b64_tr_b16 v[112:113], v20 offset:8192
  ds_read_b64_tr_b16 v[114:115], v21 offset:8192
  ds_read_b64_tr_b16 v[116:117], v22 offset:8192
  ds_read_b64_tr_b16 v[118:119], v23 offset:8192
  s_waitcnt lgkmcnt(8)
  v_mfma_f32_16x16x32_bf16 v[64:67], v[128:131], v[28:31], v[64:67]
  v_mfma_f32_16x16x32_bf16 v[68:71], v[132:135], v[28:31], v[68:71]
  v_mfma_f32_16x16x32_bf16 v[56:59], v[120:123], v[28:31], v[56:59]
  v_mfma_f32_16x16x32_bf16 v[60:63], v[124:127], v[28:31], v[60:63]
  s_waitcnt lgkmcnt(4)
  ds_read_b64_tr_b16 v[120:121], v16 offset:12288
  ds_read_b64_tr_b16 v[122:123], v17 offset:12288
  ds_read_b64_tr_b16 v[124:125], v18 offset:12288
  ds_read_b64_tr_b16 v[126:127], v19 offset:12288
  ds_read_b64_tr_b16 v[128:129], v20 offset:12288
  ds_read_b64_tr_b16 v[130:131], v21 offset:12288
  ds_read_b64_tr_b16 v[132:133], v22 offset:12288
  ds_read_b64_tr_b16 v[134:135], v23 offset:12288
  s_waitcnt lgkmcnt(8)
  v_mfma_f32_16x16x32_bf16 v[64:67], v[112:115], v[32:35], v[64:67]
  v_mfma_f32_16x16x32_bf16 v[68:71], v[116:119], v[32:35], v[68:71]
  v_mfma_f32_16x16x32_bf16 v[56:59], v[104:107], v[32:35], v[56:59]
  v_mfma_f32_16x16x32_bf16 v[60:63], v[108:111], v[32:35], v[60:63]
  s_waitcnt lgkmcnt(0)
  v_mfma_f32_16x16x32_bf16 v[64:67], v[128:131], v[36:39], v[64:67]
  v_mfma_f32_16x16x32_bf16 v[68:71], v[132:135], v[36:39], v[68:71]
  v_mfma_f32_16x16x32_bf16 v[56:59], v[120:123], v[36:39], v[56:59]
  v_mfma_f32_16x16x32_bf16 v[60:63], v[124:127], v[36:39], v[60:63]
  s_nop 4
  ds_write_b128 v4, v[64:67] offset:0
  ds_write_b128 v4, v[68:71] offset:1024
  s_waitcnt lgkmcnt(0)
  s_waitcnt vmcnt(8)
  s_barrier
  ds_read_b64_tr_b16 v[104:105], v12 offset:16384
  ds_read_b64_tr_b16 v[106:107], v12 offset:17408
  ds_read_b64_tr_b16 v[108:109], v13 offset:16384
  ds_read_b64_tr_b16 v[110:111], v13 offset:17408
  ds_read_b64_tr_b16 v[112:113], v14 offset:16384
  ds_read_b64_tr_b16 v[114:115], v14 offset:17408
  ds_read_b64_tr_b16 v[116:117], v15 offset:16384
  ds_read_b64_tr_b16 v[118:119], v15 offset:17408
  s_waitcnt lgkmcnt(2)
  ds_read_b64_tr_b16 v[120:121], v12 offset:24576
  ds_read_b64_tr_b16 v[122:123], v12 offset:25600
  ds_read_b64_tr_b16 v[124:125], v13 offset:24576
  ds_read_b64_tr_b16 v[126:127], v13 offset:25600
  ds_read_b64_tr_b16 v[128:129], v14 offset:24576
  ds_read_b64_tr_b16 v[130:131], v14 offset:25600
  ds_read_b64_tr_b16 v[132:133], v15 offset:24576
  ds_read_b64_tr_b16 v[134:135], v15 offset:25600
  s_waitcnt lgkmcnt(8)
  v_mfma_f32_16x16x32_bf16 v[48:51], v[112:115], v[80:83], v[48:51]
  v_mfma_f32_16x16x32_bf16 v[52:55], v[116:119], v[80:83], v[52:55]
  v_mfma_f32_16x16x32_bf16 v[40:43], v[104:107], v[80:83], v[40:43]
  v_mfma_f32_16x16x32_bf16 v[44:47], v[108:111], v[80:83], v[44:47]
  s_waitcnt lgkmcnt(0)
  v_mfma_f32_16x16x32_bf16 v[48:51], v[128:131], v[84:87], v[48:51]
  v_mfma_f32_16x16x32_bf16 v[52:55], v[132:135], v[84:87], v[52:55]
  v_mfma_f32_16x16x32_bf16 v[40:43], v[120:123], v[84:87], v[40:43]
  v_mfma_f32_16x16x32_bf16 v[44:47], v[124:127], v[84:87], v[44:47]
  ds_read_b128 v[24:27], v5 offset:0
  ds_read_b128 v[28:31], v5 offset:1024
  s_waitcnt lgkmcnt(0)
  v_add_f32 v56, v56, v24
  v_add_f32 v57, v57, v25
  v_add_f32 v58, v58, v26
  v_add_f32 v59, v59, v27
  v_add_f32 v60, v60, v28
  v_add_f32 v61, v61, v29
  v_add_f32 v62, v62, v30
  v_add_f32 v63, v63, v31
  v_cvt_pk_bf16_f32 v136, v56, v57
  v_cvt_pk_bf16_f32 v137, v58, v59
  v_cvt_pk_bf16_f32 v138, v60, v61
  v_cvt_pk_bf16_f32 v139, v62, v63
  s_nop 0
  v_permlane16_swap_b32 v136, v138
  v_permlane16_swap_b32 v137, v139
  buffer_store_dwordx4 v[136:139], v10, s[12:15], s34 offen
  s_waitcnt vmcnt(5)
  s_barrier
  ds_read_b64_tr_b16 v[104:105], v12 offset:32768
  ds_read_b64_tr_b16 v[106:107], v12 offset:33792
  ds_read_b64_tr_b16 v[108:109], v13 offset:32768
  ds_read_b64_tr_b16 v[110:111], v13 offset:33792
  ds_read_b64_tr_b16 v[112:113], v14 offset:32768
  ds_read_b64_tr_b16 v[114:115], v14 offset:33792
  ds_read_b64_tr_b16 v[116:117], v15 offset:32768
  ds_read_b64_tr_b16 v[118:119], v15 offset:33792
  s_waitcnt lgkmcnt(2)
  ds_read_b64_tr_b16 v[120:121], v12 offset:40960
  ds_read_b64_tr_b16 v[122:123], v12 offset:41984
  ds_read_b64_tr_b16 v[124:125], v13 offset:40960
  ds_read_b64_tr_b16 v[126:127], v13 offset:41984
  ds_read_b64_tr_b16 v[128:129], v14 offset:40960
  ds_read_b64_tr_b16 v[130:131], v14 offset:41984
  ds_read_b64_tr_b16 v[132:133], v15 offset:40960
  ds_read_b64_tr_b16 v[134:135], v15 offset:41984
  s_waitcnt lgkmcnt(8)
  v_mfma_f32_16x16x32_bf16 v[48:51], v[112:115], v[88:91], v[48:51]
  v_mfma_f32_16x16x32_bf16 v[52:55], v[116:119], v[88:91], v[52:55]
  v_mfma_f32_16x16x32_bf16 v[40:43], v[104:107], v[88:91], v[40:43]
  v_mfma_f32_16x16x32_bf16 v[44:47], v[108:111], v[88:91], v[44:47]
  s_waitcnt lgkmcnt(0)
  v_mfma_f32_16x16x32_bf16 v[48:51], v[128:131], v[92:95], v[48:51]
  v_mfma_f32_16x16x32_bf16 v[52:55], v[132:135], v[92:95], v[52:55]
  v_mfma_f32_16x16x32_bf16 v[40:43], v[120:123], v[92:95], v[40:43]
  v_mfma_f32_16x16x32_bf16 v[44:47], v[124:127], v[92:95], v[44:47]
  s_waitcnt vmcnt(1)
  s_barrier
  ds_read_b64_tr_b16 v[104:105], v12 offset:49152
  ds_read_b64_tr_b16 v[106:107], v12 offset:50176
  ds_read_b64_tr_b16 v[108:109], v13 offset:49152
  ds_read_b64_tr_b16 v[110:111], v13 offset:50176
  ds_read_b64_tr_b16 v[112:113], v14 offset:49152
  ds_read_b64_tr_b16 v[114:115], v14 offset:50176
  ds_read_b64_tr_b16 v[116:117], v15 offset:49152
  ds_read_b64_tr_b16 v[118:119], v15 offset:50176
  s_waitcnt lgkmcnt(2)
  ds_read_b64_tr_b16 v[120:121], v12 offset:57344
  ds_read_b64_tr_b16 v[122:123], v12 offset:58368
  ds_read_b64_tr_b16 v[124:125], v13 offset:57344
  ds_read_b64_tr_b16 v[126:127], v13 offset:58368
  ds_read_b64_tr_b16 v[128:129], v14 offset:57344
  ds_read_b64_tr_b16 v[130:131], v14 offset:58368
  ds_read_b64_tr_b16 v[132:133], v15 offset:57344
  ds_read_b64_tr_b16 v[134:135], v15 offset:58368
  s_waitcnt lgkmcnt(8)
  v_mfma_f32_16x16x32_bf16 v[48:51], v[112:115], v[96:99], v[48:51]
  v_mfma_f32_16x16x32_bf16 v[52:55], v[116:119], v[96:99], v[52:55]
  v_mfma_f32_16x16x32_bf16 v[40:43], v[104:107], v[96:99], v[40:43]
  v_mfma_f32_16x16x32_bf16 v[44:47], v[108:111], v[96:99], v[44:47]
  s_waitcnt lgkmcnt(0)
  v_mfma_f32_16x16x32_bf16 v[48:51], v[128:131], v[100:103], v[48:51]
  v_mfma_f32_16x16x32_bf16 v[52:55], v[132:135], v[100:103], v[52:55]
  v_mfma_f32_16x16x32_bf16 v[40:43], v[120:123], v[100:103], v[40:43]
  v_mfma_f32_16x16x32_bf16 v[44:47], v[124:127], v[100:103], v[44:47]
  s_nop 4
  ds_write_b128 v4, v[48:51] offset:2048
  ds_write_b128 v4, v[52:55] offset:3072
  s_waitcnt lgkmcnt(0)
  s_barrier
  ds_read_b128 v[32:35], v5 offset:2048
  ds_read_b128 v[36:39], v5 offset:3072
  s_waitcnt lgkmcnt(0)
  v_add_f32 v40, v40, v32
  v_add_f32 v41, v41, v33
  v_add_f32 v42, v42, v34
  v_add_f32 v43, v43, v35
  v_add_f32 v44, v44, v36
  v_add_f32 v45, v45, v37
  v_add_f32 v46, v46, v38
  v_add_f32 v47, v47, v39
  v_cvt_pk_bf16_f32 v140, v40, v41
  v_cvt_pk_bf16_f32 v141, v42, v43
  v_cvt_pk_bf16_f32 v142, v44, v45
  v_cvt_pk_bf16_f32 v143, v46, v47
  s_nop 0
  v_permlane16_swap_b32 v140, v142
  v_permlane16_swap_b32 v141, v143
  buffer_store_dwordx4 v[140:143], v3, s[12:15], s35 offen
K2_END:
  s_endpgm
.section .rodata,"a"
.p2align 6
.amdhsa_kernel fn_stage1_kernel
  .amdhsa_next_free_vgpr 172
  .amdhsa_next_free_sgpr 102
  .amdhsa_accum_offset 172
  .amdhsa_group_segment_fixed_size 0
  .amdhsa_kernarg_size 88
  .amdhsa_user_sgpr_count 2
  .amdhsa_user_sgpr_kernarg_segment_ptr 1
  .amdhsa_system_sgpr_workgroup_id_x 1
.end_amdhsa_kernel
.p2align 6
.amdhsa_kernel fn_stage2_kernel
  .amdhsa_next_free_vgpr 152
  .amdhsa_next_free_sgpr 102
  .amdhsa_accum_offset 152
  .amdhsa_group_segment_fixed_size 0
  .amdhsa_kernarg_size 88
  .amdhsa_user_sgpr_count 2
  .amdhsa_user_sgpr_kernarg_segment_ptr 1
  .amdhsa_system_sgpr_workgroup_id_x 1
.end_amdhsa_kernel
```
